```python
import torch

def _softmax(x, axis=-1):
    return torch.softmax(x, dim=axis)
def _gelu(x):
    return torch.nn.functional.gelu(x, approximate="tanh")
def _silu(x):
    return torch.nn.functional.silu(x)
def _sigmoid(x):
    return torch.sigmoid(x)
def _layernorm(x, axis=-1, eps=1e-5):
    m = x.mean(dim=axis, keepdim=True)
    v = x.var(dim=axis, keepdim=True, unbiased=False)
    return (x - m) / torch.sqrt(v + eps)
def _scatter_add(tgt, idx, src, axis=0):
    return tgt.clone().index_add_(axis, idx, src)
def _segment_sum(src, seg, n):
    out = torch.zeros((n,) + src.shape[1:], dtype=src.dtype)
    return out.index_add_(0, seg, src)
def _pad(x, pw):
    flat = tuple(v for pair in reversed(pw) for v in pair)
    return torch.nn.functional.pad(x, flat)

kernel_name = 'gather_scatter__edge_featured_mpnn_gatedgcn__graph'

def setup_inputs():

    _w = (lambda a: (lambda t: t.to(torch.bfloat16) if t.is_floating_point() else t)(torch.as_tensor(a)))
    N, deg, D, De = 50000, 16, 64, max(16, 1)
    E = N * deg
    return {
        "x": _w((lambda *s: torch.randn(*s, dtype=torch.bfloat16) * 0.4)(N, D)),
        "e_attr": _w((lambda *s: torch.randn(*s, dtype=torch.bfloat16) * 0.8)(E, De)),
        "src": _w((lambda lo, hi, *s: torch.randint(lo, hi, s))(0, N, E).to(torch.int64)),
        "dst": _w((lambda lo, hi, *s: torch.randint(lo, hi, s))(0, N, E).to(torch.int64)),
        "w_a": _w((lambda *s: torch.randn(*s, dtype=torch.bfloat16) * 0.8)(D, D)),
        "w_b": _w((lambda *s: torch.randn(*s, dtype=torch.bfloat16) * 0.4)(D, D)),
        "w_c": _w((lambda *s: torch.randn(*s, dtype=torch.bfloat16) * 0.8)(De, D)),
        "w_u": _w((lambda *s: torch.randn(*s, dtype=torch.bfloat16) * 0.05)(D, D)),
        "w_v": _w((lambda *s: torch.randn(*s, dtype=torch.bfloat16) * 0.05)(D, D)),
    }

def reference(x, e_attr, src, dst, w_a, w_b, w_c, w_u, w_v):
    N, D = x.shape
    hv = x @ w_v
    g = x[dst] @ w_a + x[src] @ w_b + e_attr @ w_c
    eta = _sigmoid(g)
    denom = _segment_sum(eta, dst, N) + 1e-6
    eta_n = eta / denom[dst]
    agg = _segment_sum(eta_n * hv[src], dst, N)
    z = x @ w_u + agg
    relu_z = torch.where(z > 0, z, 0 * z)
    return x + relu_z
```

```asm
; @launch kernel=prep_kernel grid=(251,1,1) block=(1024,1,1) lds=40832
; @launch kernel=main_kernel grid=(250,1,1) block=(512,1,1) lds=156928
.amdgcn_target "amdgcn-amd-amdhsa--gfx950"
.text
.globl prep_kernel
.p2align 8
.type prep_kernel,@function
prep_kernel:
    s_cmp_gt_u32 s2, 250
    s_cbranch_scc1 PREP_END2
    s_load_dwordx4 s[4:7], s[0:1], 16
    s_load_dwordx2 s[8:9], s[0:1], 88
    s_cmp_eq_u32 s2, 250
    s_cbranch_scc1 PREP_W
    s_waitcnt lgkmcnt(0)
    s_mov_b32 s12, s6
    s_mov_b32 s13, s7
    s_and_b32 s13, s13, 0xffff
    s_mov_b32 s14, 3200000
    s_mov_b32 s15, 0x00020000
    s_mov_b32 s16, s4
    s_mov_b32 s17, s5
    s_and_b32 s17, s17, 0xffff
    s_mov_b32 s18, 3200000
    s_mov_b32 s19, 0x00020000
    s_add_u32 s20, s8, 65536
    s_addc_u32 s21, s9, 0
    s_and_b32 s21, s21, 0xffff
    s_mov_b32 s22, 2000000
    s_mov_b32 s23, 0x00020000
    s_add_u32 s24, s8, 4194304
    s_addc_u32 s25, s9, 0
    s_and_b32 s25, s25, 0xffff
    s_mov_b32 s26, 6400000
    s_mov_b32 s27, 0x00020000
    s_mul_i32 s3, s2, 12800
    v_lshl_add_u32 v1, v0, 4, s3
    v_cmp_gt_u32 vcc, 800, v0
    s_nop 0
    s_mov_b64 s[30:31], vcc
    v_cmp_gt_u32 vcc, 500, v0
    s_nop 0
    s_mov_b64 s[32:33], vcc
    v_mov_b32 v40, 0
    v_mov_b32 v41, 0
    v_mov_b32 v42, 0
    v_mov_b32 v43, 0
    v_lshlrev_b32 v2, 4, v0
    s_mov_b64 exec, s[30:31]
    s_nop 0
    s_cbranch_execz PREP_A
    buffer_load_dwordx4 v[4:7], v1, s[12:15], 0 offen
    buffer_load_dwordx4 v[8:11], v1, s[16:19], 0 offen
PREP_A:
    s_mov_b64 exec, s[32:33]
    s_cbranch_execz PREP_A2
    ds_write_b128 v2, v[40:43]
PREP_A2:
    s_mov_b64 exec, -1
    s_waitcnt lgkmcnt(0)
    s_barrier
    s_mov_b64 exec, s[30:31]
    s_cbranch_execz PREP_B
    s_mov_b32 s34, 171798692
    v_mov_b32 v3, 1
    s_waitcnt vmcnt(0)
    v_mul_hi_u32 v12, v4, s34
    v_mul_hi_u32 v13, v5, s34
    v_mul_hi_u32 v14, v6, s34
    v_mul_hi_u32 v15, v7, s34
    v_mul_u32_u24 v16, 25, v12
    v_mul_u32_u24 v17, 25, v13
    v_mul_u32_u24 v18, 25, v14
    v_mul_u32_u24 v19, 25, v15
    v_sub_u32 v16, v4, v16
    v_sub_u32 v17, v5, v17
    v_sub_u32 v18, v6, v18
    v_sub_u32 v19, v7, v19
    v_lshlrev_b32 v12, 2, v12
    v_lshlrev_b32 v13, 2, v13
    v_lshlrev_b32 v14, 2, v14
    v_lshlrev_b32 v15, 2, v15
    ds_add_rtn_u32 v20, v12, v3
    ds_add_rtn_u32 v21, v13, v3
    ds_add_rtn_u32 v22, v14, v3
    ds_add_rtn_u32 v23, v15, v3
    s_mul_i32 s35, s2, 3200
    v_lshl_add_u32 v32, v0, 2, s35
    v_lshl_or_b32 v24, v8, 7, v16
    v_lshrrev_b32 v33, 5, v12
    v_lshl_or_b32 v24, v33, 23, v24
    v_add_u32 v25, 0, v32
    v_bfe_u32 v33, v12, 2, 3
    v_lshl_or_b32 v25, v25, 5, v33
    v_lshl_or_b32 v26, v9, 7, v17
    v_lshrrev_b32 v33, 5, v13
    v_lshl_or_b32 v26, v33, 23, v26
    v_add_u32 v27, 1, v32
    v_bfe_u32 v33, v13, 2, 3
    v_lshl_or_b32 v27, v27, 5, v33
    v_lshl_or_b32 v28, v10, 7, v18
    v_lshrrev_b32 v33, 5, v14
    v_lshl_or_b32 v28, v33, 23, v28
    v_add_u32 v29, 2, v32
    v_bfe_u32 v33, v14, 2, 3
    v_lshl_or_b32 v29, v29, 5, v33
    v_lshl_or_b32 v30, v11, 7, v19
    v_lshrrev_b32 v33, 5, v15
    v_lshl_or_b32 v30, v33, 23, v30
    v_add_u32 v31, 3, v32
    v_bfe_u32 v33, v15, 2, 3
    v_lshl_or_b32 v31, v31, 5, v33
    s_waitcnt lgkmcnt(0)
    s_nop 0
PREP_B:
    s_mov_b64 exec, -1
    s_barrier
    s_mov_b64 exec, s[32:33]
    s_cbranch_execz PREP_C
    ds_read_b128 v[40:43], v2
    s_waitcnt lgkmcnt(0)
PREP_C:
    s_mov_b64 exec, -1
    v_add_u32 v44, v40, v41
    v_add_u32 v45, v44, v42
    v_add_u32 v46, v45, v43
    v_mov_b32 v47, v46
    s_nop 1
    v_add_u32_dpp v47, v47, v47 row_shr:1 row_mask:0xf bank_mask:0xf bound_ctrl:0
    s_nop 1
    v_add_u32_dpp v47, v47, v47 row_shr:2 row_mask:0xf bank_mask:0xf bound_ctrl:0
    s_nop 1
    v_add_u32_dpp v47, v47, v47 row_shr:4 row_mask:0xf bank_mask:0xf bound_ctrl:0
    s_nop 1
    v_add_u32_dpp v47, v47, v47 row_shr:8 row_mask:0xf bank_mask:0xf bound_ctrl:0
    s_nop 1
    v_add_u32_dpp v47, v47, v47 row_bcast:15 row_mask:0xa bank_mask:0xf
    s_nop 1
    v_add_u32_dpp v47, v47, v47 row_bcast:31 row_mask:0xc bank_mask:0xf
    v_lshrrev_b32 v48, 6, v0
    v_and_b32 v49, 63, v0
    v_readfirstlane_b32 s36, v48
    v_lshlrev_b32 v50, 2, v48
    v_add_u32 v50, 8000, v50
    v_cmp_eq_u32 vcc, 63, v49
    s_nop 0
    s_and_saveexec_b64 s[38:39], vcc
    ds_write_b32 v50, v47
    s_mov_b64 exec, -1
    s_waitcnt lgkmcnt(0)
    s_barrier
    v_and_b32 v51, 15, v49
    v_lshlrev_b32 v50, 2, v51
    v_add_u32 v50, 8000, v50
    ds_read_b32 v52, v50
    v_cmp_gt_u32 vcc, s36, v51
    s_waitcnt lgkmcnt(0)
    s_nop 0
    v_cndmask_b32 v52, 0, v52, vcc
    s_nop 1
    v_add_u32_dpp v52, v52, v52 row_shr:1 row_mask:0xf bank_mask:0xf bound_ctrl:0
    s_nop 1
    v_add_u32_dpp v52, v52, v52 row_shr:2 row_mask:0xf bank_mask:0xf bound_ctrl:0
    s_nop 1
    v_add_u32_dpp v52, v52, v52 row_shr:4 row_mask:0xf bank_mask:0xf bound_ctrl:0
    s_nop 1
    v_add_u32_dpp v52, v52, v52 row_shr:8 row_mask:0xf bank_mask:0xf bound_ctrl:0
    s_nop 0
    v_readlane_b32 s37, v52, 15
    v_sub_u32 v47, v47, v46
    s_nop 0
    v_add_u32 v47, s37, v47
    v_mov_b32 v56, v47
    v_add_u32 v57, v47, v40
    v_add_u32 v58, v47, v44
    v_add_u32 v59, v47, v45
    v_lshl_or_b32 v60, v40, 16, v56
    v_lshl_or_b32 v61, v41, 16, v57
    v_lshl_or_b32 v62, v42, 16, v58
    v_lshl_or_b32 v63, v43, 16, v59
    v_lshrrev_b32 v53, 1, v0
    v_mul_u32_u24 v53, 8000, v53
    v_and_b32 v54, 1, v0
    v_lshl_add_u32 v53, v54, 4, v53
    s_lshl_b32 s3, s2, 5
    v_add_u32 v53, s3, v53
    s_mov_b64 exec, s[32:33]
    s_nop 0
    s_cbranch_execz PREP_D
    ds_write_b128 v2, v[56:59]
    buffer_store_dwordx4 v[60:63], v53, s[20:23], 0 offen
    s_nop 1
PREP_D:
    s_mov_b64 exec, -1
    s_waitcnt lgkmcnt(0)
    s_barrier
    s_mov_b64 exec, s[30:31]
    s_cbranch_execz PREP_E
    ds_read_b32 v12, v12
    ds_read_b32 v13, v13
    ds_read_b32 v14, v14
    ds_read_b32 v15, v15
    s_waitcnt lgkmcnt(0)
    v_add_u32 v12, v12, v20
    v_lshlrev_b32 v12, 3, v12
    ds_write_b64 v12, v[24:25] offset:8064
    v_add_u32 v13, v13, v21
    v_lshlrev_b32 v13, 3, v13
    ds_write_b64 v13, v[26:27] offset:8064
    v_add_u32 v14, v14, v22
    v_lshlrev_b32 v14, 3, v14
    ds_write_b64 v14, v[28:29] offset:8064
    v_add_u32 v15, v15, v23
    v_lshlrev_b32 v15, 3, v15
    ds_write_b64 v15, v[30:31] offset:8064
    s_nop 0
PREP_E:
    s_mov_b64 exec, -1
    s_waitcnt lgkmcnt(0)
    s_barrier
    s_add_u32 s40, s8, 16777216
    s_addc_u32 s41, s9, 0
    s_and_b32 s41, s41, 0xffff
    s_mov_b32 s42, 16000000
    s_mov_b32 s43, 0x00020000
    v_lshlrev_b32 v2, 3, v0
    ds_read_b64 v[24:25], v2 offset:8064
    ds_read_b64 v[26:27], v2 offset:16256
    ds_read_b64 v[28:29], v2 offset:24448
    ds_read_b64 v[30:31], v2 offset:32640
    s_waitcnt lgkmcnt(0)
    v_lshrrev_b32 v12, 23, v24
    v_min_u32 v12, 249, v12
    v_lshlrev_b32 v16, 5, v12
    ds_read_b32 v16, v16
    v_lshrrev_b32 v13, 23, v26
    v_min_u32 v13, 249, v13
    v_lshlrev_b32 v17, 5, v13
    ds_read_b32 v17, v17
    v_lshrrev_b32 v14, 23, v28
    v_min_u32 v14, 249, v14
    v_lshlrev_b32 v18, 5, v14
    ds_read_b32 v18, v18
    v_lshrrev_b32 v15, 23, v30
    v_min_u32 v15, 249, v15
    v_lshlrev_b32 v19, 5, v15
    ds_read_b32 v19, v19
    s_mul_i32 s35, s2, 3200
    s_lshl_b32 s36, s2, 5
    s_waitcnt lgkmcnt(0)
    s_mov_b64 s[44:45], 0
    v_add_u32 v20, 0, v0
    v_sub_u32 v21, v20, v16
    v_mul_u32_u24 v22, 8000, v12
    v_add3_u32 v22, v22, v21, s36
    v_lshlrev_b32 v22, 3, v22
    v_cmp_gt_u32 vcc, 3200, v20
    s_nop 0
    s_mov_b64 s[46:47], vcc
    v_cmp_gt_u32 vcc, 32, v21
    s_nop 0
    s_and_b64 exec, vcc, s[46:47]
    buffer_store_dwordx2 v[24:25], v22, s[40:43], 0 offen
    s_andn2_b64 exec, s[46:47], vcc
    s_nop 0
    s_cbranch_execz PREP_NOVF0
    v_add_u32 v22, s35, v20
    v_lshlrev_b32 v22, 3, v22
    buffer_store_dwordx2 v[24:25], v22, s[24:27], 0 offen
    s_nop 0
PREP_NOVF0:
    s_mov_b64 exec, -1
    v_add_u32 v20, 1024, v0
    v_sub_u32 v21, v20, v17
    v_mul_u32_u24 v22, 8000, v13
    v_add3_u32 v22, v22, v21, s36
    v_lshlrev_b32 v22, 3, v22
    v_cmp_gt_u32 vcc, 3200, v20
    s_nop 0
    s_mov_b64 s[46:47], vcc
    v_cmp_gt_u32 vcc, 32, v21
    s_nop 0
    s_and_b64 exec, vcc, s[46:47]
    buffer_store_dwordx2 v[26:27], v22, s[40:43], 0 offen
    s_andn2_b64 exec, s[46:47], vcc
    s_nop 0
    s_cbranch_execz PREP_NOVF1
    v_add_u32 v22, s35, v20
    v_lshlrev_b32 v22, 3, v22
    buffer_store_dwordx2 v[26:27], v22, s[24:27], 0 offen
    s_nop 0
PREP_NOVF1:
    s_mov_b64 exec, -1
    v_add_u32 v20, 2048, v0
    v_sub_u32 v21, v20, v18
    v_mul_u32_u24 v22, 8000, v14
    v_add3_u32 v22, v22, v21, s36
    v_lshlrev_b32 v22, 3, v22
    v_cmp_gt_u32 vcc, 3200, v20
    s_nop 0
    s_mov_b64 s[46:47], vcc
    v_cmp_gt_u32 vcc, 32, v21
    s_nop 0
    s_and_b64 exec, vcc, s[46:47]
    buffer_store_dwordx2 v[28:29], v22, s[40:43], 0 offen
    s_andn2_b64 exec, s[46:47], vcc
    s_nop 0
    s_cbranch_execz PREP_NOVF2
    v_add_u32 v22, s35, v20
    v_lshlrev_b32 v22, 3, v22
    buffer_store_dwordx2 v[28:29], v22, s[24:27], 0 offen
    s_nop 0
PREP_NOVF2:
    s_mov_b64 exec, -1
    v_add_u32 v20, 3072, v0
    v_sub_u32 v21, v20, v19
    v_mul_u32_u24 v22, 8000, v15
    v_add3_u32 v22, v22, v21, s36
    v_lshlrev_b32 v22, 3, v22
    v_cmp_gt_u32 vcc, 3200, v20
    s_nop 0
    s_mov_b64 s[46:47], vcc
    v_cmp_gt_u32 vcc, 32, v21
    s_nop 0
    s_and_b64 exec, vcc, s[46:47]
    buffer_store_dwordx2 v[30:31], v22, s[40:43], 0 offen
    s_andn2_b64 exec, s[46:47], vcc
    s_nop 0
    s_cbranch_execz PREP_NOVF3
    v_add_u32 v22, s35, v20
    v_lshlrev_b32 v22, 3, v22
    buffer_store_dwordx2 v[30:31], v22, s[24:27], 0 offen
    s_nop 0
PREP_NOVF3:
    s_mov_b64 exec, -1
    s_branch PREP_END
PREP_W:
    s_load_dwordx4 s[12:15], s[0:1], 32
    s_load_dwordx4 s[16:19], s[0:1], 48
    s_load_dwordx2 s[20:21], s[0:1], 64
    s_waitcnt lgkmcnt(0)
    s_mov_b32 s24, s8
    s_mov_b32 s25, s9
    s_and_b32 s25, s25, 0xffff
    s_mov_b32 s26, 65536
    s_mov_b32 s27, 0x00020000
    s_mov_b32 s28, s12
    s_mov_b32 s29, s13
    s_and_b32 s29, s29, 0xffff
    s_mov_b32 s30, 8192
    s_mov_b32 s31, 0x00020000
    s_mov_b32 s32, s14
    s_mov_b32 s33, s15
    s_and_b32 s33, s33, 0xffff
    s_mov_b32 s34, 8192
    s_mov_b32 s35, 0x00020000
    s_mov_b32 s36, s16
    s_mov_b32 s37, s17
    s_and_b32 s37, s37, 0xffff
    s_mov_b32 s38, 2048
    s_mov_b32 s39, 0x00020000
    s_mov_b32 s40, s18
    s_mov_b32 s41, s19
    s_and_b32 s41, s41, 0xffff
    s_mov_b32 s42, 8192
    s_mov_b32 s43, 0x00020000
    s_mov_b32 s44, s20
    s_mov_b32 s45, s21
    s_and_b32 s45, s45, 0xffff
    s_mov_b32 s46, 8192
    s_mov_b32 s47, 0x00020000
    v_and_b32 v1, 31, v0
    v_bfe_u32 v2, v0, 5, 1
    v_bfe_u32 v3, v0, 6, 1
    v_bfe_u32 v4, v0, 7, 2
    v_lshlrev_b32 v5, 12, v2
    v_lshl_add_u32 v5, v4, 10, v5
    v_lshl_add_u32 v5, v1, 2, v5
    v_lshl_add_u32 v5, v3, 1, v5
    v_lshlrev_b32 v6, 4, v0
    v_cmp_gt_u32 vcc, 512, v0
    s_nop 0
    s_and_saveexec_b64 s[48:49], vcc
    s_nop 2
    s_cbranch_execz PREP_W2
    buffer_load_ushort v8, v5, s[32:35], 0 offen offset:0
    buffer_load_ushort v9, v5, s[32:35], 0 offen offset:128
    buffer_load_ushort v10, v5, s[32:35], 0 offen offset:256
    buffer_load_ushort v11, v5, s[32:35], 0 offen offset:384
    buffer_load_ushort v12, v5, s[32:35], 0 offen offset:512
    buffer_load_ushort v13, v5, s[32:35], 0 offen offset:640
    buffer_load_ushort v14, v5, s[32:35], 0 offen offset:768
    buffer_load_ushort v15, v5, s[32:35], 0 offen offset:896
    buffer_load_ushort v16, v5, s[44:47], 0 offen offset:0
    buffer_load_ushort v17, v5, s[44:47], 0 offen offset:128
    buffer_load_ushort v18, v5, s[44:47], 0 offen offset:256
    buffer_load_ushort v19, v5, s[44:47], 0 offen offset:384
    buffer_load_ushort v20, v5, s[44:47], 0 offen offset:512
    buffer_load_ushort v21, v5, s[44:47], 0 offen offset:640
    buffer_load_ushort v22, v5, s[44:47], 0 offen offset:768
    buffer_load_ushort v23, v5, s[44:47], 0 offen offset:896
    buffer_load_ushort v24, v5, s[28:31], 0 offen offset:0
    buffer_load_ushort v25, v5, s[28:31], 0 offen offset:128
    buffer_load_ushort v26, v5, s[28:31], 0 offen offset:256
    buffer_load_ushort v27, v5, s[28:31], 0 offen offset:384
    buffer_load_ushort v28, v5, s[28:31], 0 offen offset:512
    buffer_load_ushort v29, v5, s[28:31], 0 offen offset:640
    buffer_load_ushort v30, v5, s[28:31], 0 offen offset:768
    buffer_load_ushort v31, v5, s[28:31], 0 offen offset:896
    buffer_load_ushort v32, v5, s[40:43], 0 offen offset:0
    buffer_load_ushort v33, v5, s[40:43], 0 offen offset:128
    buffer_load_ushort v34, v5, s[40:43], 0 offen offset:256
    buffer_load_ushort v35, v5, s[40:43], 0 offen offset:384
    buffer_load_ushort v36, v5, s[40:43], 0 offen offset:512
    buffer_load_ushort v37, v5, s[40:43], 0 offen offset:640
    buffer_load_ushort v38, v5, s[40:43], 0 offen offset:768
    buffer_load_ushort v39, v5, s[40:43], 0 offen offset:896
    v_mov_b32 v60, 0xbfb8aa3b
    s_waitcnt vmcnt(24)
    v_lshlrev_b32 v8, 16, v8
    v_lshlrev_b32 v9, 16, v9
    v_mul_f32 v8, v60, v8
    v_mul_f32 v9, v60, v9
    v_cvt_pk_bf16_f32 v40, v8, v9
    v_lshlrev_b32 v10, 16, v10
    v_lshlrev_b32 v11, 16, v11
    v_mul_f32 v10, v60, v10
    v_mul_f32 v11, v60, v11
    v_cvt_pk_bf16_f32 v41, v10, v11
    v_lshlrev_b32 v12, 16, v12
    v_lshlrev_b32 v13, 16, v13
    v_mul_f32 v12, v60, v12
    v_mul_f32 v13, v60, v13
    v_cvt_pk_bf16_f32 v42, v12, v13
    v_lshlrev_b32 v14, 16, v14
    v_lshlrev_b32 v15, 16, v15
    v_mul_f32 v14, v60, v14
    v_mul_f32 v15, v60, v15
    v_cvt_pk_bf16_f32 v43, v14, v15
    s_mov_b32 s50, 0
    buffer_store_dwordx4 v[40:43], v6, s[24:27], s50 offen
    s_waitcnt vmcnt(17)
    v_lshl_or_b32 v44, v17, 16, v16
    v_lshl_or_b32 v45, v19, 16, v18
    v_lshl_or_b32 v46, v21, 16, v20
    v_lshl_or_b32 v47, v23, 16, v22
    s_mov_b32 s50, 8192
    buffer_store_dwordx4 v[44:47], v6, s[24:27], s50 offen
    s_waitcnt vmcnt(10)
    v_lshl_or_b32 v48, v25, 16, v24
    v_lshl_or_b32 v49, v27, 16, v26
    v_lshl_or_b32 v50, v29, 16, v28
    v_lshl_or_b32 v51, v31, 16, v30
    s_mov_b32 s50, 16384
    buffer_store_dwordx4 v[48:51], v6, s[24:27], s50 offen
    s_waitcnt vmcnt(3)
    v_lshl_or_b32 v52, v33, 16, v32
    v_lshl_or_b32 v53, v35, 16, v34
    v_lshl_or_b32 v54, v37, 16, v36
    v_lshl_or_b32 v55, v39, 16, v38
    s_mov_b32 s50, 32768
    buffer_store_dwordx4 v[52:55], v6, s[24:27], s50 offen
    s_nop 1
PREP_W2:
    s_mov_b64 exec, -1
    v_subrev_u32 v7, 512, v0
    v_cmp_gt_u32 vcc, 128, v7
    s_nop 0
    s_and_saveexec_b64 s[48:49], vcc
    s_nop 2
    s_cbranch_execz PREP_END
    v_lshlrev_b32 v5, 10, v2
    v_lshl_add_u32 v5, v1, 2, v5
    v_lshl_add_u32 v5, v3, 1, v5
    v_lshlrev_b32 v6, 4, v7
    buffer_load_ushort v8, v5, s[36:39], 0 offen offset:0
    buffer_load_ushort v9, v5, s[36:39], 0 offen offset:128
    buffer_load_ushort v10, v5, s[36:39], 0 offen offset:256
    buffer_load_ushort v11, v5, s[36:39], 0 offen offset:384
    buffer_load_ushort v12, v5, s[36:39], 0 offen offset:512
    buffer_load_ushort v13, v5, s[36:39], 0 offen offset:640
    buffer_load_ushort v14, v5, s[36:39], 0 offen offset:768
    buffer_load_ushort v15, v5, s[36:39], 0 offen offset:896
    s_waitcnt vmcnt(0)
    v_mov_b32 v60, 0xbfb8aa3b
    v_lshlrev_b32 v8, 16, v8
    v_lshlrev_b32 v9, 16, v9
    v_mul_f32 v8, v60, v8
    v_mul_f32 v9, v60, v9
    v_cvt_pk_bf16_f32 v16, v8, v9
    v_lshlrev_b32 v10, 16, v10
    v_lshlrev_b32 v11, 16, v11
    v_mul_f32 v10, v60, v10
    v_mul_f32 v11, v60, v11
    v_cvt_pk_bf16_f32 v17, v10, v11
    v_lshlrev_b32 v12, 16, v12
    v_lshlrev_b32 v13, 16, v13
    v_mul_f32 v12, v60, v12
    v_mul_f32 v13, v60, v13
    v_cvt_pk_bf16_f32 v18, v12, v13
    v_lshlrev_b32 v14, 16, v14
    v_lshlrev_b32 v15, 16, v15
    v_mul_f32 v14, v60, v14
    v_mul_f32 v15, v60, v15
    v_cvt_pk_bf16_f32 v19, v14, v15
    s_mov_b32 s50, 24576
    buffer_store_dwordx4 v[16:19], v6, s[24:27], s50 offen
    s_nop 1
PREP_END:
PREP_END2:
    s_endpgm
.globl main_kernel
.p2align 8
.type main_kernel,@function
main_kernel:
    s_cmp_ge_u32 s2, 250
    s_cbranch_scc1 MAIN_END
    s_load_dwordx4 s[4:7], s[0:1], 0
    s_load_dwordx2 s[32:33], s[0:1], 72
    s_load_dwordx2 s[34:35], s[0:1], 88
    v_lshrrev_b32 v1, 6, v0
    s_nop 0
    v_readfirstlane_b32 s36, v1
    v_and_b32 v1, 63, v0
    v_and_b32 v2, 31, v0
    v_bfe_u32 v3, v0, 5, 1
    v_lshlrev_b32 v4, 6, v3
    v_lshlrev_b32 v5, 4, v3
    v_and_b32 v7, 15, v0
    s_lshl_b32 s37, s2, 3
    s_add_u32 s37, s37, s36
    s_mul_i32 s38, s37, 25
    s_mul_i32 s43, s36, 18432
    s_add_u32 s43, s43, 9472
    s_mov_b32 s48, 512
    s_mov_b32 s49, 18432
    v_mov_b32 v11, 0xbfb8aa3b
    v_mov_b32 v14, 0x10001
    v_mov_b32 v15, 0x3f80
    v_mov_b32 v248, 0x007fff80
    v_mov_b32 v249, 0xffffffe0
    v_lshlrev_b32 v6, 2, v2
    v_add_u32 v6, s43, v6
    s_waitcnt lgkmcnt(0)
    s_add_u32 s20, s34, 65536
    s_addc_u32 s21, s35, 0
    s_and_b32 s21, s21, 0xffff
    s_mov_b32 s22, 2000000
    s_mov_b32 s23, 0x00020000
    s_mov_b32 s16, s34
    s_mov_b32 s17, s35
    s_and_b32 s17, s17, 0xffff
    s_mov_b32 s18, 26624
    s_mov_b32 s19, 0x00020000
    s_add_u32 s56, s34, 16777216
    s_addc_u32 s57, s35, 0
    s_and_b32 s57, s57, 0xffff
    s_mov_b32 s58, 16000000
    s_mov_b32 s59, 0x00020000
    s_mul_i32 s45, s2, 8000
    v_lshl_add_u32 v240, v0, 5, s45
    v_mov_b32 v243, 1073741824
    v_cmp_gt_u32 vcc, 250, v0
    s_nop 1
    v_cndmask_b32 v240, v243, v240, vcc
    buffer_load_dwordx4 v[152:155], v240, s[20:23], 0 offen
    buffer_load_dwordx4 v[156:159], v240, s[20:23], 0 offen offset:16
    v_lshlrev_b32 v242, 4, v0
    s_mov_b32 s45, 0
    buffer_load_dwordx4 v[168:171], v242, s[16:19], s45 offen
    s_mov_b32 s45, 8192
    buffer_load_dwordx4 v[172:175], v242, s[16:19], s45 offen
    s_mov_b32 s45, 16384
    buffer_load_dwordx4 v[176:179], v242, s[16:19], s45 offen
    s_mov_b32 s45, 24576
    buffer_load_dwordx4 v[180:183], v242, s[16:19], s45 offen
    s_mov_b32 s8, s4
    s_mov_b32 s9, s5
    s_and_b32 s9, s9, 0xffff
    s_mov_b32 s10, 6400000
    s_mov_b32 s11, 0x00020000
    s_mov_b32 s12, s6
    s_mov_b32 s13, s7
    s_and_b32 s13, s13, 0xffff
    s_mov_b32 s14, 25600000
    s_mov_b32 s15, 0x00020000
    s_mov_b32 s16, s34
    s_mov_b32 s17, s35
    s_and_b32 s17, s17, 0xffff
    s_mov_b32 s18, 65536
    s_mov_b32 s19, 0x00020000
    s_add_u32 s24, s34, 4194304
    s_addc_u32 s25, s35, 0
    s_and_b32 s25, s25, 0xffff
    s_mov_b32 s26, 6400000
    s_mov_b32 s27, 0x00020000
    s_mov_b32 s28, s32
    s_mov_b32 s29, s33
    s_and_b32 s29, s29, 0xffff
    s_mov_b32 s30, 6400000
    s_mov_b32 s31, 0x00020000
    v_mov_b32 v88, 0
    v_mov_b32 v89, 0
    v_mov_b32 v90, 0
    v_mov_b32 v91, 0
    v_mov_b32 v92, 0
    v_mov_b32 v93, 0
    v_mov_b32 v94, 0
    v_mov_b32 v95, 0
    v_mov_b32 v96, 0
    v_mov_b32 v97, 0
    v_mov_b32 v98, 0
    v_mov_b32 v99, 0
    v_mov_b32 v100, 0
    v_mov_b32 v101, 0
    v_mov_b32 v102, 0
    v_mov_b32 v103, 0
    v_mov_b32 v104, 0
    v_mov_b32 v105, 0
    v_mov_b32 v106, 0
    v_mov_b32 v107, 0
    v_mov_b32 v108, 0
    v_mov_b32 v109, 0
    v_mov_b32 v110, 0
    v_mov_b32 v111, 0
    v_mov_b32 v112, 0
    v_mov_b32 v113, 0
    v_mov_b32 v114, 0
    v_mov_b32 v115, 0
    v_mov_b32 v116, 0
    v_mov_b32 v117, 0
    v_mov_b32 v118, 0
    v_mov_b32 v119, 0
    s_waitcnt vmcnt(4)
    v_lshlrev_b32 v240, 2, v0
    v_lshrrev_b32 v244, 16, v152
    v_lshrrev_b32 v245, 16, v153
    v_add_u32 v244, v244, v245
    v_lshrrev_b32 v245, 16, v154
    v_add_u32 v244, v244, v245
    v_lshrrev_b32 v245, 16, v155
    v_add_u32 v244, v244, v245
    v_lshrrev_b32 v245, 16, v156
    v_add_u32 v244, v244, v245
    v_lshrrev_b32 v245, 16, v157
    v_add_u32 v244, v244, v245
    v_lshrrev_b32 v245, 16, v158
    v_add_u32 v244, v244, v245
    v_lshrrev_b32 v245, 16, v159
    v_add_u32 v244, v244, v245
    v_lshl_or_b32 v244, v152, 16, v244
    v_cmp_gt_u32 vcc, 256, v0
    s_nop 0
    s_and_saveexec_b64 s[52:53], vcc
    s_nop 2
    s_cbranch_execz DSC_SKIP
    ds_write_b32 v240, v152 offset:0
    ds_write_b32 v240, v153 offset:1024
    ds_write_b32 v240, v154 offset:2048
    ds_write_b32 v240, v155 offset:3072
    ds_write_b32 v240, v156 offset:4096
    ds_write_b32 v240, v157 offset:5120
    ds_write_b32 v240, v158 offset:6144
    ds_write_b32 v240, v159 offset:7168
    ds_write_b32 v240, v244 offset:8192
DSC_SKIP:
    s_mov_b64 exec, -1
    s_waitcnt vmcnt(0)
    ds_write_b128 v242, v[168:171] offset:9472
    ds_write_b128 v242, v[172:175] offset:27904
    ds_write_b128 v242, v[176:179] offset:46336
    v_cmp_gt_u32 vcc, 128, v0
    s_nop 0
    s_and_saveexec_b64 s[52:53], vcc
    s_nop 2
    s_cbranch_execz WST_SKIP
    ds_write_b128 v242, v[180:183] offset:17664
WST_SKIP:
    s_mov_b64 exec, -1
    s_waitcnt lgkmcnt(0)
    s_barrier
    v_lshrrev_b32 v242, 3, v0
    v_lshlrev_b32 v242, 8, v242
    v_and_b32 v243, 7, v0
    v_lshl_add_u32 v242, v243, 4, v242
    s_mul_i32 s45, s2, 64000
    s_add_u32 s45, s45, 0
    buffer_load_dwordx4 v[208:211], v242, s[56:59], s45 offen
    s_mul_i32 s45, s2, 64000
    s_add_u32 s45, s45, 16384
    buffer_load_dwordx4 v[212:215], v242, s[56:59], s45 offen
    s_mul_i32 s45, s2, 64000
    s_add_u32 s45, s45, 32768
    buffer_load_dwordx4 v[216:219], v242, s[56:59], s45 offen
    s_mul_i32 s45, s2, 64000
    s_add_u32 s45, s45, 49152
    buffer_load_dwordx4 v[220:223], v242, s[56:59], s45 offen
    s_lshl_b32 s45, s36, 10
    v_lshl_add_u32 v240, v1, 2, s45
    v_lshlrev_b32 v241, 2, v1
    ds_read_b32 v152, v240 offset:0
    ds_read_b32 v153, v240 offset:256
    ds_read_b32 v154, v240 offset:512
    ds_read_b32 v155, v240 offset:768
    ds_read_b32 v192, v241 offset:8192
    ds_read_b32 v193, v241 offset:8448
    ds_read_b32 v194, v241 offset:8704
    ds_read_b32 v195, v241 offset:8960
    v_lshlrev_b32 v242, 4, v1
    ds_read_b128 v[120:123], v242 offset:46336
    ds_read_b128 v[124:127], v242 offset:47360
    ds_read_b128 v[128:131], v242 offset:48384
    ds_read_b128 v[132:135], v242 offset:49408
    ds_read_b128 v[136:139], v242 offset:50432
    ds_read_b128 v[140:143], v242 offset:51456
    ds_read_b128 v[144:147], v242 offset:52480
    ds_read_b128 v[148:151], v242 offset:53504
    ds_read_b128 v[16:19], v242 offset:9472
    ds_read_b128 v[20:23], v242 offset:10496
    ds_read_b128 v[24:27], v242 offset:11520
    ds_read_b128 v[28:31], v242 offset:12544
    ds_read_b128 v[32:35], v242 offset:13568
    ds_read_b128 v[36:39], v242 offset:14592
    ds_read_b128 v[40:43], v242 offset:15616
    ds_read_b128 v[44:47], v242 offset:16640
    ds_read_b128 v[48:51], v242 offset:27904
    ds_read_b128 v[52:55], v242 offset:28928
    ds_read_b128 v[56:59], v242 offset:29952
    ds_read_b128 v[60:63], v242 offset:30976
    ds_read_b128 v[64:67], v242 offset:32000
    ds_read_b128 v[68:71], v242 offset:33024
    ds_read_b128 v[72:75], v242 offset:34048
    ds_read_b128 v[76:79], v242 offset:35072
    ds_read_b128 v[80:83], v242 offset:17664
    ds_read_b128 v[84:87], v242 offset:18688
    s_waitcnt lgkmcnt(15)
    v_lshrrev_b32 v184, 16, v152
    v_and_b32 v188, 0xffff, v152
    v_lshrrev_b32 v185, 16, v153
    v_and_b32 v189, 0xffff, v153
    v_lshrrev_b32 v186, 16, v154
    v_and_b32 v190, 0xffff, v154
    v_lshrrev_b32 v187, 16, v155
    v_and_b32 v191, 0xffff, v155
    v_add_u32 v196, v184, v185
    v_add3_u32 v196, v196, v186, v187
    v_mov_b32 v197, v196
    s_nop 1
    v_add_u32_dpp v197, v197, v197 row_shr:1 row_mask:0xf bank_mask:0xf bound_ctrl:0
    s_nop 1
    v_add_u32_dpp v197, v197, v197 row_shr:2 row_mask:0xf bank_mask:0xf bound_ctrl:0
    s_nop 1
    v_add_u32_dpp v197, v197, v197 row_shr:4 row_mask:0xf bank_mask:0xf bound_ctrl:0
    s_nop 1
    v_add_u32_dpp v197, v197, v197 row_shr:8 row_mask:0xf bank_mask:0xf bound_ctrl:0
    s_nop 1
    v_add_u32_dpp v197, v197, v197 row_bcast:15 row_mask:0xa bank_mask:0xf
    s_nop 1
    v_add_u32_dpp v197, v197, v197 row_bcast:31 row_mask:0xc bank_mask:0xf
    s_nop 0
    v_readlane_b32 s40, v197, 63
    v_sub_u32 v200, v197, v196
    v_add_u32 v201, v200, v184
    v_add_u32 v202, v201, v185
    v_add_u32 v203, v202, v186
    v_lshrrev_b32 v192, 16, v192
    v_sub_u32 v200, v200, v188
    v_add_u32 v200, v200, v192
    ds_write_b32 v240, v200 offset:0
    v_lshrrev_b32 v193, 16, v193
    v_sub_u32 v201, v201, v189
    v_add_u32 v201, v201, v193
    ds_write_b32 v240, v201 offset:256
    v_lshrrev_b32 v194, 16, v194
    v_sub_u32 v202, v202, v190
    v_add_u32 v202, v202, v194
    ds_write_b32 v240, v202 offset:512
    v_lshrrev_b32 v195, 16, v195
    v_sub_u32 v203, v203, v191
    v_add_u32 v203, v203, v195
    ds_write_b32 v240, v203 offset:768
    v_mov_b32 v196, s40
    s_lshl_b32 s45, s36, 2
    v_mov_b32 v197, s45
    ds_write_b32 v197, v196 offset:9216
    s_waitcnt lgkmcnt(0)
    s_barrier
    v_mov_b32 v197, 0
    ds_read_b128 v[184:187], v197 offset:9216
    ds_read_b128 v[188:191], v197 offset:9232
    s_waitcnt lgkmcnt(0)
    v_max3_u32 v184, v184, v185, v186
    v_max3_u32 v184, v184, v187, v188
    v_max3_u32 v184, v184, v189, v190
    v_max_u32 v184, v184, v191
    s_nop 0
    v_readfirstlane_b32 s47, v184
    s_mov_b32 s41, 0
    s_nop 3
ROUND:
    s_sub_u32 s46, s40, s41
    s_cselect_b32 s46, 0, s46
    s_min_u32 s46, s46, 512
    v_mov_b32 v172, 0x007fff80
    v_mov_b32 v173, 1073741824
    v_add_u32 v168, s46, v1
    v_lshl_add_u32 v169, v168, 3, s43
    ds_write_b64 v169, v[172:173] offset:8192
    ds_write_b64 v169, v[172:173] offset:8704
    v_lshl_add_u32 v169, v168, 2, s43
    v_mov_b32 v170, 7936
    ds_write_b32 v169, v170 offset:13312
    ds_write_b32 v169, v170 offset:13568
    v_lshl_add_u32 v169, v168, 1, s43
    v_mov_b32 v170, 0
    ds_write_b16 v169, v170 offset:15872
    ds_write_b16 v169, v170 offset:16000
    ds_write_b16 v169, v170 offset:17152
    ds_write_b16 v169, v170 offset:17280
    v_lshrrev_b32 v174, 3, v0
    v_lshlrev_b32 v174, 2, v174
    v_and_b32 v175, 7, v0
    v_lshlrev_b32 v175, 1, v175
    ds_read_b32 v184, v174 offset:8192
    ds_read_b32 v185, v174 offset:8448
    ds_read_b32 v186, v174 offset:8704
    ds_read_b32 v187, v174 offset:8960
    v_mov_b32 v171, 18432
    v_lshrrev_b32 v242, 3, v0
    v_lshlrev_b32 v242, 8, v242
    v_and_b32 v243, 7, v0
    v_lshl_add_u32 v242, v243, 4, v242
    v_mov_b32 v243, 1073741824
    v_add_u32 v12, 16, v175
    s_waitcnt lgkmcnt(0)
    v_and_b32 v184, 0xffff, v184
    v_and_b32 v185, 0xffff, v185
    v_and_b32 v186, 0xffff, v186
    v_and_b32 v187, 0xffff, v187
    v_cmp_lt_u32 vcc, v12, v184
    s_nop 1
    v_cndmask_b32 v244, v243, v242, vcc
    s_mul_i32 s45, s2, 64000
    s_add_u32 s45, s45, 128
    buffer_load_dwordx4 v[224:227], v244, s[56:59], s45 offen
    v_cmp_lt_u32 vcc, v12, v185
    s_nop 1
    v_cndmask_b32 v245, v243, v242, vcc
    s_mul_i32 s45, s2, 64000
    s_add_u32 s45, s45, 16512
    buffer_load_dwordx4 v[228:231], v245, s[56:59], s45 offen
    v_cmp_lt_u32 vcc, v12, v186
    s_nop 1
    v_cndmask_b32 v246, v243, v242, vcc
    s_mul_i32 s45, s2, 64000
    s_add_u32 s45, s45, 32896
    buffer_load_dwordx4 v[232:235], v246, s[56:59], s45 offen
    v_cmp_lt_u32 vcc, v12, v187
    s_nop 1
    v_cndmask_b32 v247, v243, v242, vcc
    s_mul_i32 s45, s2, 64000
    s_add_u32 s45, s45, 49280
    buffer_load_dwordx4 v[236:239], v247, s[56:59], s45 offen
    s_waitcnt vmcnt(4)
    v_add_u32 v12, 1, v175
    v_subrev_u32 v176, s41, v175
    v_add_u32 v13, 1, v176
    v_and_b32 v177, 7, v209
    v_lshl_add_u32 v183, v177, 10, v174
    ds_read_b32 v200, v183 offset:0
    v_and_b32 v177, 7, v211
    v_lshl_add_u32 v183, v177, 10, v174
    ds_read_b32 v201, v183 offset:0
    v_and_b32 v177, 7, v213
    v_lshl_add_u32 v183, v177, 10, v174
    ds_read_b32 v202, v183 offset:256
    v_and_b32 v177, 7, v215
    v_lshl_add_u32 v183, v177, 10, v174
    ds_read_b32 v203, v183 offset:256
    v_and_b32 v177, 7, v217
    v_lshl_add_u32 v183, v177, 10, v174
    ds_read_b32 v204, v183 offset:512
    v_and_b32 v177, 7, v219
    v_lshl_add_u32 v183, v177, 10, v174
    ds_read_b32 v205, v183 offset:512
    v_and_b32 v177, 7, v221
    v_lshl_add_u32 v183, v177, 10, v174
    ds_read_b32 v206, v183 offset:768
    v_and_b32 v177, 7, v223
    v_lshl_add_u32 v183, v177, 10, v174
    ds_read_b32 v207, v183 offset:768
    s_waitcnt lgkmcnt(0)
    v_add_u32 v178, v200, v176
    v_and_b32 v177, 7, v209
    v_mul_u32_u24 v179, v177, v171
    v_cmp_lt_u32 vcc, v175, v184
    v_cmp_gt_u32 s[52:53], s48, v178
    v_lshl_add_u32 v183, v178, 3, v179
    s_and_b64 exec, vcc, s[52:53]
    ds_write_b64 v183, v[208:209] offset:17664
    s_mov_b64 exec, -1
    v_add_u32 v178, v201, v13
    v_and_b32 v177, 7, v211
    v_mul_u32_u24 v179, v177, v171
    v_cmp_lt_u32 vcc, v12, v184
    v_cmp_gt_u32 s[52:53], s48, v178
    v_lshl_add_u32 v183, v178, 3, v179
    s_and_b64 exec, vcc, s[52:53]
    ds_write_b64 v183, v[210:211] offset:17664
    s_mov_b64 exec, -1
    v_add_u32 v178, v202, v176
    v_and_b32 v177, 7, v213
    v_mul_u32_u24 v179, v177, v171
    v_cmp_lt_u32 vcc, v175, v185
    v_cmp_gt_u32 s[52:53], s48, v178
    v_lshl_add_u32 v183, v178, 3, v179
    s_and_b64 exec, vcc, s[52:53]
    ds_write_b64 v183, v[212:213] offset:17664
    s_mov_b64 exec, -1
    v_add_u32 v178, v203, v13
    v_and_b32 v177, 7, v215
    v_mul_u32_u24 v179, v177, v171
    v_cmp_lt_u32 vcc, v12, v185
    v_cmp_gt_u32 s[52:53], s48, v178
    v_lshl_add_u32 v183, v178, 3, v179
    s_and_b64 exec, vcc, s[52:53]
    ds_write_b64 v183, v[214:215] offset:17664
    s_mov_b64 exec, -1
    v_add_u32 v178, v204, v176
    v_and_b32 v177, 7, v217
    v_mul_u32_u24 v179, v177, v171
    v_cmp_lt_u32 vcc, v175, v186
    v_cmp_gt_u32 s[52:53], s48, v178
    v_lshl_add_u32 v183, v178, 3, v179
    s_and_b64 exec, vcc, s[52:53]
    ds_write_b64 v183, v[216:217] offset:17664
    s_mov_b64 exec, -1
    v_add_u32 v178, v205, v13
    v_and_b32 v177, 7, v219
    v_mul_u32_u24 v179, v177, v171
    v_cmp_lt_u32 vcc, v12, v186
    v_cmp_gt_u32 s[52:53], s48, v178
    v_lshl_add_u32 v183, v178, 3, v179
    s_and_b64 exec, vcc, s[52:53]
    ds_write_b64 v183, v[218:219] offset:17664
    s_mov_b64 exec, -1
    v_add_u32 v178, v206, v176
    v_and_b32 v177, 7, v221
    v_mul_u32_u24 v179, v177, v171
    v_cmp_lt_u32 vcc, v175, v187
    v_cmp_gt_u32 s[52:53], s48, v178
    v_lshl_add_u32 v183, v178, 3, v179
    s_and_b64 exec, vcc, s[52:53]
    ds_write_b64 v183, v[220:221] offset:17664
    s_mov_b64 exec, -1
    v_add_u32 v178, v207, v13
    v_and_b32 v177, 7, v223
    v_mul_u32_u24 v179, v177, v171
    v_cmp_lt_u32 vcc, v12, v187
    v_cmp_gt_u32 s[52:53], s48, v178
    v_lshl_add_u32 v183, v178, 3, v179
    s_and_b64 exec, vcc, s[52:53]
    ds_write_b64 v183, v[222:223] offset:17664
    s_mov_b64 exec, -1
    v_add_u32 v175, 16, v175
    s_cmp_lg_u32 s41, 0
    s_nop 0
    s_cbranch_scc1 XO_SKIP
    v_add_u32 v183, s38, v2
    v_lshl_add_u32 v183, v183, 7, v4
    buffer_load_dwordx4 v[208:211], v183, s[8:11], 0 offen offset:0
    buffer_load_dwordx4 v[212:215], v183, s[8:11], 0 offen offset:16
    buffer_load_dwordx4 v[216:219], v183, s[8:11], 0 offen offset:32
    buffer_load_dwordx4 v[220:223], v183, s[8:11], 0 offen offset:48
XO_SKIP:
    s_waitcnt vmcnt(4)
    s_cmp_eq_u32 s41, 0
    s_cbranch_scc1 L2_OK
    s_waitcnt vmcnt(0)
L2_OK:
    v_add_u32 v12, 1, v175
    v_subrev_u32 v176, s41, v175
    v_add_u32 v13, 1, v176
    v_and_b32 v177, 7, v225
    v_lshl_add_u32 v183, v177, 10, v174
    ds_read_b32 v200, v183 offset:0
    v_and_b32 v177, 7, v227
    v_lshl_add_u32 v183, v177, 10, v174
    ds_read_b32 v201, v183 offset:0
    v_and_b32 v177, 7, v229
    v_lshl_add_u32 v183, v177, 10, v174
    ds_read_b32 v202, v183 offset:256
    v_and_b32 v177, 7, v231
    v_lshl_add_u32 v183, v177, 10, v174
    ds_read_b32 v203, v183 offset:256
    v_and_b32 v177, 7, v233
    v_lshl_add_u32 v183, v177, 10, v174
    ds_read_b32 v204, v183 offset:512
    v_and_b32 v177, 7, v235
    v_lshl_add_u32 v183, v177, 10, v174
    ds_read_b32 v205, v183 offset:512
    v_and_b32 v177, 7, v237
    v_lshl_add_u32 v183, v177, 10, v174
    ds_read_b32 v206, v183 offset:768
    v_and_b32 v177, 7, v239
    v_lshl_add_u32 v183, v177, 10, v174
    ds_read_b32 v207, v183 offset:768
    s_waitcnt lgkmcnt(0)
    v_add_u32 v178, v200, v176
    v_and_b32 v177, 7, v225
    v_mul_u32_u24 v179, v177, v171
    v_cmp_lt_u32 vcc, v175, v184
    v_cmp_gt_u32 s[52:53], s48, v178
    v_lshl_add_u32 v183, v178, 3, v179
    s_and_b64 exec, vcc, s[52:53]
    ds_write_b64 v183, v[224:225] offset:17664
    s_mov_b64 exec, -1
    v_add_u32 v178, v201, v13
    v_and_b32 v177, 7, v227
    v_mul_u32_u24 v179, v177, v171
    v_cmp_lt_u32 vcc, v12, v184
    v_cmp_gt_u32 s[52:53], s48, v178
    v_lshl_add_u32 v183, v178, 3, v179
    s_and_b64 exec, vcc, s[52:53]
    ds_write_b64 v183, v[226:227] offset:17664
    s_mov_b64 exec, -1
    v_add_u32 v178, v202, v176
    v_and_b32 v177, 7, v229
    v_mul_u32_u24 v179, v177, v171
    v_cmp_lt_u32 vcc, v175, v185
    v_cmp_gt_u32 s[52:53], s48, v178
    v_lshl_add_u32 v183, v178, 3, v179
    s_and_b64 exec, vcc, s[52:53]
    ds_write_b64 v183, v[228:229] offset:17664
    s_mov_b64 exec, -1
    v_add_u32 v178, v203, v13
    v_and_b32 v177, 7, v231
    v_mul_u32_u24 v179, v177, v171
    v_cmp_lt_u32 vcc, v12, v185
    v_cmp_gt_u32 s[52:53], s48, v178
    v_lshl_add_u32 v183, v178, 3, v179
    s_and_b64 exec, vcc, s[52:53]
    ds_write_b64 v183, v[230:231] offset:17664
    s_mov_b64 exec, -1
    v_add_u32 v178, v204, v176
    v_and_b32 v177, 7, v233
    v_mul_u32_u24 v179, v177, v171
    v_cmp_lt_u32 vcc, v175, v186
    v_cmp_gt_u32 s[52:53], s48, v178
    v_lshl_add_u32 v183, v178, 3, v179
    s_and_b64 exec, vcc, s[52:53]
    ds_write_b64 v183, v[232:233] offset:17664
    s_mov_b64 exec, -1
    v_add_u32 v178, v205, v13
    v_and_b32 v177, 7, v235
    v_mul_u32_u24 v179, v177, v171
    v_cmp_lt_u32 vcc, v12, v186
    v_cmp_gt_u32 s[52:53], s48, v178
    v_lshl_add_u32 v183, v178, 3, v179
    s_and_b64 exec, vcc, s[52:53]
    ds_write_b64 v183, v[234:235] offset:17664
    s_mov_b64 exec, -1
    v_add_u32 v178, v206, v176
    v_and_b32 v177, 7, v237
    v_mul_u32_u24 v179, v177, v171
    v_cmp_lt_u32 vcc, v175, v187
    v_cmp_gt_u32 s[52:53], s48, v178
    v_lshl_add_u32 v183, v178, 3, v179
    s_and_b64 exec, vcc, s[52:53]
    ds_write_b64 v183, v[236:237] offset:17664
    s_mov_b64 exec, -1
    v_add_u32 v178, v207, v13
    v_and_b32 v177, 7, v239
    v_mul_u32_u24 v179, v177, v171
    v_cmp_lt_u32 vcc, v12, v187
    v_cmp_gt_u32 s[52:53], s48, v178
    v_lshl_add_u32 v183, v178, 3, v179
    s_and_b64 exec, vcc, s[52:53]
    ds_write_b64 v183, v[238:239] offset:17664
    s_mov_b64 exec, -1
    v_lshlrev_b32 v169, 2, v0
    v_and_b32 v169, 0x3ff, v169
    ds_read_b32 v184, v169 offset:8192
    s_waitcnt lgkmcnt(0)
    v_lshrrev_b32 v186, 16, v184
    v_and_b32 v184, 0xffff, v184
    v_cmp_gt_u32 vcc, 256, v0
    s_nop 1
    v_cndmask_b32 v184, 0, v184, vcc
    v_mul_u32_u24 v185, 3200, v0
    v_add_u32 v186, v186, v185
    v_mov_b32 v185, 32
    s_nop 1
OVF:
    v_cmp_lt_u32 vcc, v185, v184
    s_nop 1
    s_cbranch_vccz OVF_DONE
    v_add_u32 v190, v186, v185
    v_lshlrev_b32 v190, 3, v190
    v_mov_b32 v191, 1073741824
    v_cndmask_b32 v190, v191, v190, vcc
    buffer_load_dwordx2 v[188:189], v190, s[24:27], 0 offen
    s_waitcnt vmcnt(0)
    v_and_b32 v177, 7, v189
    v_lshl_add_u32 v183, v177, 10, v169
    ds_read_b32 v190, v183 offset:0
    v_subrev_u32 v191, s41, v185
    s_waitcnt lgkmcnt(0)
    v_add_u32 v178, v190, v191
    v_and_b32 v177, 7, v189
    v_mul_u32_u24 v179, v177, v171
    v_cmp_lt_u32 vcc, v185, v184
    v_cmp_gt_u32 s[52:53], s48, v178
    v_lshl_add_u32 v183, v178, 3, v179
    s_and_b64 exec, vcc, s[52:53]
    ds_write_b64 v183, v[188:189] offset:17664
    s_mov_b64 exec, -1
    v_add_u32 v185, 1, v185
    s_nop 1
    s_branch OVF
OVF_DONE:
    s_waitcnt lgkmcnt(0)
    s_barrier
    v_lshl_add_u32 v12, v1, 3, s43
    ds_read_b32 v152, v12 offset:8192
    ds_read_b32 v153, v12 offset:8704
    ds_read_b32 v154, v12 offset:9216
    ds_read_b32 v155, v12 offset:9728
    ds_read_b32 v156, v12 offset:10240
    ds_read_b32 v157, v12 offset:10752
    ds_read_b32 v158, v12 offset:11264
    ds_read_b32 v159, v12 offset:11776
    v_lshl_add_u32 v184, v1, 2, s43
    v_lshl_add_u32 v185, v1, 1, s43
    s_waitcnt lgkmcnt(0)
    v_add_u32 v186, 0, v1
    v_cmp_gt_u32 vcc, s46, v186
    s_nop 0
    s_and_b64 exec, exec, vcc
    s_nop 2
    s_cbranch_execz DRV_DONE
    v_and_b32 v152, 31, v152
    v_lshlrev_b32 v187, v152, 1
    v_lshrrev_b32 v188, 16, v187
    v_lshlrev_b32 v152, 8, v152
    ds_write_b32 v184, v152 offset:13312
    ds_write_b16 v185, v187 offset:15872
    ds_write_b16 v185, v188 offset:17152
    v_add_u32 v186, 64, v1
    v_cmp_gt_u32 vcc, s46, v186
    s_nop 0
    s_and_b64 exec, exec, vcc
    s_nop 2
    s_cbranch_execz DRV_DONE
    v_and_b32 v153, 31, v153
    v_lshlrev_b32 v187, v153, 1
    v_lshrrev_b32 v188, 16, v187
    v_lshlrev_b32 v153, 8, v153
    ds_write_b32 v184, v153 offset:13568
    ds_write_b16 v185, v187 offset:16000
    ds_write_b16 v185, v188 offset:17280
    v_add_u32 v186, 128, v1
    v_cmp_gt_u32 vcc, s46, v186
    s_nop 0
    s_and_b64 exec, exec, vcc
    s_nop 2
    s_cbranch_execz DRV_DONE
    v_and_b32 v154, 31, v154
    v_lshlrev_b32 v187, v154, 1
    v_lshrrev_b32 v188, 16, v187
    v_lshlrev_b32 v154, 8, v154
    ds_write_b32 v184, v154 offset:13824
    ds_write_b16 v185, v187 offset:16128
    ds_write_b16 v185, v188 offset:17408
    v_add_u32 v186, 192, v1
    v_cmp_gt_u32 vcc, s46, v186
    s_nop 0
    s_and_b64 exec, exec, vcc
    s_nop 2
    s_cbranch_execz DRV_DONE
    v_and_b32 v155, 31, v155
    v_lshlrev_b32 v187, v155, 1
    v_lshrrev_b32 v188, 16, v187
    v_lshlrev_b32 v155, 8, v155
    ds_write_b32 v184, v155 offset:14080
    ds_write_b16 v185, v187 offset:16256
    ds_write_b16 v185, v188 offset:17536
    v_add_u32 v186, 256, v1
    v_cmp_gt_u32 vcc, s46, v186
    s_nop 0
    s_and_b64 exec, exec, vcc
    s_nop 2
    s_cbranch_execz DRV_DONE
    v_and_b32 v156, 31, v156
    v_lshlrev_b32 v187, v156, 1
    v_lshrrev_b32 v188, 16, v187
    v_lshlrev_b32 v156, 8, v156
    ds_write_b32 v184, v156 offset:14336
    ds_write_b16 v185, v187 offset:16384
    ds_write_b16 v185, v188 offset:17664
    v_add_u32 v186, 320, v1
    v_cmp_gt_u32 vcc, s46, v186
    s_nop 0
    s_and_b64 exec, exec, vcc
    s_nop 2
    s_cbranch_execz DRV_DONE
    v_and_b32 v157, 31, v157
    v_lshlrev_b32 v187, v157, 1
    v_lshrrev_b32 v188, 16, v187
    v_lshlrev_b32 v157, 8, v157
    ds_write_b32 v184, v157 offset:14592
    ds_write_b16 v185, v187 offset:16512
    ds_write_b16 v185, v188 offset:17792
    v_add_u32 v186, 384, v1
    v_cmp_gt_u32 vcc, s46, v186
    s_nop 0
    s_and_b64 exec, exec, vcc
    s_nop 2
    s_cbranch_execz DRV_DONE
    v_and_b32 v158, 31, v158
    v_lshlrev_b32 v187, v158, 1
    v_lshrrev_b32 v188, 16, v187
    v_lshlrev_b32 v158, 8, v158
    ds_write_b32 v184, v158 offset:14848
    ds_write_b16 v185, v187 offset:16640
    ds_write_b16 v185, v188 offset:17920
    v_add_u32 v186, 448, v1
    v_cmp_gt_u32 vcc, s46, v186
    s_nop 0
    s_and_b64 exec, exec, vcc
    s_nop 2
    s_cbranch_execz DRV_DONE
    v_and_b32 v159, 31, v159
    v_lshlrev_b32 v187, v159, 1
    v_lshrrev_b32 v188, 16, v187
    v_lshlrev_b32 v159, 8, v159
    ds_write_b32 v184, v159 offset:15104
    ds_write_b16 v185, v187 offset:16768
    ds_write_b16 v185, v188 offset:18048
DRV_DONE:
    s_mov_b64 exec, -1
    s_add_u32 s42, s46, 31
    s_lshr_b32 s42, s42, 5
    v_lshl_add_u32 v8, v2, 3, s43
    v_lshl_add_u32 v9, v3, 4, s43
    v_bfe_u32 v12, v2, 4, 1
    v_mul_u32_u24 v12, 1280, v12
    v_lshl_add_u32 v10, v3, 3, s43
    v_add_u32 v10, v10, v12
    ds_read_b64 v[12:13], v8 offset:8192
    s_waitcnt lgkmcnt(0)
    v_and_or_b32 v12, v12, v248, v4
    v_and_or_b32 v13, v13, v249, v5
    buffer_load_dwordx4 v[228:231], v12, s[8:11], 0 offen offset:0
    buffer_load_dwordx4 v[232:235], v12, s[8:11], 0 offen offset:16
    buffer_load_dwordx4 v[236:239], v12, s[8:11], 0 offen offset:32
    buffer_load_dwordx4 v[240:243], v12, s[8:11], 0 offen offset:48
    buffer_load_dwordx4 v[244:247], v13, s[12:15], 0 offen nt
    s_cmp_lg_u32 s41, 0
    s_cbranch_scc1 AP_DONE
    s_waitcnt vmcnt(5)
    v_lshl_add_u32 v12, v3, 10, v6
    v_mfma_f32_32x32x16_bf16 v[168:183], v[208:211], v[120:123], 0
    v_mfma_f32_32x32x16_bf16 v[168:183], v[212:215], v[128:131], v[168:183]
    v_mfma_f32_32x32x16_bf16 v[168:183], v[216:219], v[136:139], v[168:183]
    v_mfma_f32_32x32x16_bf16 v[168:183], v[220:223], v[144:147], v[168:183]
    v_mfma_f32_32x32x16_bf16 v[184:199], v[208:211], v[124:127], 0
    v_mfma_f32_32x32x16_bf16 v[184:199], v[212:215], v[132:135], v[184:199]
    v_mfma_f32_32x32x16_bf16 v[184:199], v[216:219], v[140:143], v[184:199]
    v_mfma_f32_32x32x16_bf16 v[184:199], v[220:223], v[148:151], v[184:199]
    s_nop 7
    v_mul_f32 v168, v11, v168
    ds_write_b32 v12, v168 offset:0
    v_mul_f32 v169, v11, v169
    ds_write_b32 v12, v169 offset:256
    v_mul_f32 v170, v11, v170
    ds_write_b32 v12, v170 offset:512
    v_mul_f32 v171, v11, v171
    ds_write_b32 v12, v171 offset:768
    v_mul_f32 v172, v11, v172
    ds_write_b32 v12, v172 offset:2048
    v_mul_f32 v173, v11, v173
    ds_write_b32 v12, v173 offset:2304
    v_mul_f32 v174, v11, v174
    ds_write_b32 v12, v174 offset:2560
    v_mul_f32 v175, v11, v175
    ds_write_b32 v12, v175 offset:2816
    v_mul_f32 v176, v11, v176
    ds_write_b32 v12, v176 offset:4096
    v_mul_f32 v177, v11, v177
    ds_write_b32 v12, v177 offset:4352
    v_mul_f32 v178, v11, v178
    ds_write_b32 v12, v178 offset:4608
    v_mul_f32 v179, v11, v179
    ds_write_b32 v12, v179 offset:4864
    v_mul_f32 v180, v11, v180
    ds_write_b32 v12, v180 offset:6144
    v_mul_f32 v181, v11, v181
    ds_write_b32 v12, v181 offset:6400
    v_mul_f32 v182, v11, v182
    ds_write_b32 v12, v182 offset:6656
    v_mul_f32 v183, v11, v183
    ds_write_b32 v12, v183 offset:6912
    v_mul_f32 v184, v11, v184
    ds_write_b32 v12, v184 offset:128
    v_mul_f32 v185, v11, v185
    ds_write_b32 v12, v185 offset:384
    v_mul_f32 v186, v11, v186
    ds_write_b32 v12, v186 offset:640
    v_mul_f32 v187, v11, v187
    ds_write_b32 v12, v187 offset:896
    v_mul_f32 v188, v11, v188
    ds_write_b32 v12, v188 offset:2176
    v_mul_f32 v189, v11, v189
    ds_write_b32 v12, v189 offset:2432
    v_mul_f32 v190, v11, v190
    ds_write_b32 v12, v190 offset:2688
    v_mul_f32 v191, v11, v191
    ds_write_b32 v12, v191 offset:2944
    v_mul_f32 v192, v11, v192
    ds_write_b32 v12, v192 offset:4224
    v_mul_f32 v193, v11, v193
    ds_write_b32 v12, v193 offset:4480
    v_mul_f32 v194, v11, v194
    ds_write_b32 v12, v194 offset:4736
    v_mul_f32 v195, v11, v195
    ds_write_b32 v12, v195 offset:4992
    v_mul_f32 v196, v11, v196
    ds_write_b32 v12, v196 offset:6272
    v_mul_f32 v197, v11, v197
    ds_write_b32 v12, v197 offset:6528
    v_mul_f32 v198, v11, v198
    ds_write_b32 v12, v198 offset:6784
    v_mul_f32 v199, v11, v199
    ds_write_b32 v12, v199 offset:7040
    v_mov_b32 v120, 0
    v_mov_b32 v121, 0
    v_mov_b32 v122, 0
    v_mov_b32 v123, 0
    v_mov_b32 v124, 0
    v_mov_b32 v125, 0
    v_mov_b32 v126, 0
    v_mov_b32 v127, 0
    v_mov_b32 v128, 0
    v_mov_b32 v129, 0
    v_mov_b32 v130, 0
    v_mov_b32 v131, 0
    v_mov_b32 v132, 0
    v_mov_b32 v133, 0
    v_mov_b32 v134, 0
    v_mov_b32 v135, 0
    v_mov_b32 v136, 0
    v_mov_b32 v137, 0
    v_mov_b32 v138, 0
    v_mov_b32 v139, 0
    v_mov_b32 v140, 0
    v_mov_b32 v141, 0
    v_mov_b32 v142, 0
    v_mov_b32 v143, 0
    v_mov_b32 v144, 0
    v_mov_b32 v145, 0
    v_mov_b32 v146, 0
    v_mov_b32 v147, 0
    v_mov_b32 v148, 0
    v_mov_b32 v149, 0
    v_mov_b32 v150, 0
    v_mov_b32 v151, 0
    s_nop 1
AP_DONE:
    s_cmp_eq_u32 s42, 0
    s_cbranch_scc1 LOOP_DONE
LOOP:
    ds_read_b64 v[12:13], v8 offset:8448
    ds_read_b128 v[168:171], v9 offset:13312
    ds_read_b128 v[172:175], v9 offset:13344
    ds_read_b128 v[176:179], v9 offset:13376
    ds_read_b128 v[180:183], v9 offset:13408
    ds_read_b64 v[200:201], v10 offset:15872
    ds_read_b64 v[202:203], v10 offset:15888
    ds_read_b64 v[204:205], v10 offset:15904
    ds_read_b64 v[206:207], v10 offset:15920
    s_waitcnt lgkmcnt(8)
    v_and_or_b32 v12, v12, v248, v4
    v_and_or_b32 v13, v13, v249, v5
    buffer_load_dwordx4 v[208:211], v12, s[8:11], 0 offen offset:0
    buffer_load_dwordx4 v[212:215], v12, s[8:11], 0 offen offset:16
    buffer_load_dwordx4 v[216:219], v12, s[8:11], 0 offen offset:32
    buffer_load_dwordx4 v[220:223], v12, s[8:11], 0 offen offset:48
    buffer_load_dwordx4 v[224:227], v13, s[12:15], 0 offen nt
    s_waitcnt lgkmcnt(4)
    v_add_u32 v168, v168, v6
    v_add_u32 v169, v169, v6
    v_add_u32 v170, v170, v6
    v_add_u32 v171, v171, v6
    v_add_u32 v172, v172, v6
    v_add_u32 v173, v173, v6
    v_add_u32 v174, v174, v6
    v_add_u32 v175, v175, v6
    v_add_u32 v176, v176, v6
    v_add_u32 v177, v177, v6
    v_add_u32 v178, v178, v6
    v_add_u32 v179, v179, v6
    v_add_u32 v180, v180, v6
    v_add_u32 v181, v181, v6
    v_add_u32 v182, v182, v6
    v_add_u32 v183, v183, v6
    ds_read_b32 v152, v168 offset:0
    ds_read_b32 v153, v169 offset:0
    ds_read_b32 v154, v170 offset:0
    ds_read_b32 v155, v171 offset:0
    ds_read_b32 v156, v172 offset:0
    ds_read_b32 v157, v173 offset:0
    ds_read_b32 v158, v174 offset:0
    ds_read_b32 v159, v175 offset:0
    ds_read_b32 v160, v176 offset:0
    ds_read_b32 v161, v177 offset:0
    ds_read_b32 v162, v178 offset:0
    ds_read_b32 v163, v179 offset:0
    ds_read_b32 v164, v180 offset:0
    ds_read_b32 v165, v181 offset:0
    ds_read_b32 v166, v182 offset:0
    ds_read_b32 v167, v183 offset:0
    ds_read_b32 v184, v168 offset:128
    ds_read_b32 v185, v169 offset:128
    ds_read_b32 v186, v170 offset:128
    ds_read_b32 v187, v171 offset:128
    ds_read_b32 v188, v172 offset:128
    ds_read_b32 v189, v173 offset:128
    ds_read_b32 v190, v174 offset:128
    ds_read_b32 v191, v175 offset:128
    ds_read_b32 v192, v176 offset:128
    ds_read_b32 v193, v177 offset:128
    ds_read_b32 v194, v178 offset:128
    ds_read_b32 v195, v179 offset:128
    ds_read_b32 v196, v180 offset:128
    ds_read_b32 v197, v181 offset:128
    ds_read_b32 v198, v182 offset:128
    ds_read_b32 v199, v183 offset:128
    s_waitcnt vmcnt(5) lgkmcnt(15)
    v_mfma_f32_32x32x16_bf16 v[152:167], v[228:231], v[16:19], v[152:167]
    v_lshrrev_b32 v200, v7, v200
    v_lshrrev_b32 v201, v7, v201
    v_lshrrev_b32 v202, v7, v202
    v_lshrrev_b32 v203, v7, v203
    v_lshrrev_b32 v204, v7, v204
    v_mfma_f32_32x32x16_bf16 v[152:167], v[232:235], v[24:27], v[152:167]
    v_lshrrev_b32 v205, v7, v205
    v_lshrrev_b32 v206, v7, v206
    v_lshrrev_b32 v207, v7, v207
    v_and_b32 v200, v14, v200
    v_and_b32 v201, v14, v201
    v_mfma_f32_32x32x16_bf16 v[152:167], v[236:239], v[32:35], v[152:167]
    v_and_b32 v202, v14, v202
    v_and_b32 v203, v14, v203
    v_and_b32 v204, v14, v204
    v_and_b32 v205, v14, v205
    v_and_b32 v206, v14, v206
    v_and_b32 v207, v14, v207
    v_mfma_f32_32x32x16_bf16 v[152:167], v[240:243], v[40:43], v[152:167]
    v_mul_u32_u24 v200, v15, v200
    v_mul_u32_u24 v201, v15, v201
    v_mul_u32_u24 v202, v15, v202
    v_mul_u32_u24 v203, v15, v203
    v_mul_u32_u24 v204, v15, v204
    v_mfma_f32_32x32x16_bf16 v[152:167], v[244:247], v[80:83], v[152:167]
    v_mul_u32_u24 v205, v15, v205
    v_mul_u32_u24 v206, v15, v206
    v_mul_u32_u24 v207, v15, v207
    v_add_u32 v8, 256, v8
    v_add_u32 v9, 128, v9
    v_add_u32 v10, 64, v10
    s_waitcnt lgkmcnt(0)
    v_mfma_f32_32x32x16_bf16 v[168:183], v[228:231], v[48:51], 0
    s_nop 3
    v_exp_f32 v152, v152
    v_exp_f32 v153, v153
    v_exp_f32 v154, v154
    v_exp_f32 v155, v155
    v_exp_f32 v156, v156
    v_mfma_f32_32x32x16_bf16 v[168:183], v[232:235], v[56:59], v[168:183]
    v_exp_f32 v157, v157
    v_exp_f32 v158, v158
    v_exp_f32 v159, v159
    v_exp_f32 v160, v160
    v_exp_f32 v161, v161
    v_mfma_f32_32x32x16_bf16 v[168:183], v[236:239], v[64:67], v[168:183]
    v_exp_f32 v162, v162
    v_exp_f32 v163, v163
    v_exp_f32 v164, v164
    v_exp_f32 v165, v165
    v_exp_f32 v166, v166
    v_exp_f32 v167, v167
    v_mfma_f32_32x32x16_bf16 v[168:183], v[240:243], v[72:75], v[168:183]
    v_add_f32 v152, 1.0, v152
    v_add_f32 v153, 1.0, v153
    v_add_f32 v154, 1.0, v154
    v_add_f32 v155, 1.0, v155
    v_add_f32 v156, 1.0, v156
    v_mfma_f32_32x32x16_bf16 v[184:199], v[228:231], v[20:23], v[184:199]
    v_add_f32 v157, 1.0, v157
    v_add_f32 v158, 1.0, v158
    v_add_f32 v159, 1.0, v159
    v_add_f32 v160, 1.0, v160
    v_add_f32 v161, 1.0, v161
    v_mfma_f32_32x32x16_bf16 v[184:199], v[232:235], v[28:31], v[184:199]
    v_add_f32 v162, 1.0, v162
    v_add_f32 v163, 1.0, v163
    v_add_f32 v164, 1.0, v164
    v_add_f32 v165, 1.0, v165
    v_add_f32 v166, 1.0, v166
    v_add_f32 v167, 1.0, v167
    v_mfma_f32_32x32x16_bf16 v[184:199], v[236:239], v[36:39], v[184:199]
    v_rcp_f32 v152, v152
    v_rcp_f32 v153, v153
    v_rcp_f32 v154, v154
    v_rcp_f32 v155, v155
    v_rcp_f32 v156, v156
    v_mfma_f32_32x32x16_bf16 v[184:199], v[240:243], v[44:47], v[184:199]
    v_rcp_f32 v157, v157
    v_rcp_f32 v158, v158
    v_rcp_f32 v159, v159
    v_rcp_f32 v160, v160
    v_rcp_f32 v161, v161
    v_mfma_f32_32x32x16_bf16 v[184:199], v[244:247], v[84:87], v[184:199]
    v_rcp_f32 v162, v162
    v_rcp_f32 v163, v163
    v_rcp_f32 v164, v164
    v_rcp_f32 v165, v165
    v_rcp_f32 v166, v166
    v_rcp_f32 v167, v167
    v_mul_f32 v168, v168, v152
    v_mul_f32 v169, v169, v153
    v_mul_f32 v170, v170, v154
    v_mul_f32 v171, v171, v155
    v_mul_f32 v172, v172, v156
    v_mul_f32 v173, v173, v157
    v_mul_f32 v174, v174, v158
    v_mul_f32 v175, v175, v159
    v_mul_f32 v176, v176, v160
    v_mul_f32 v177, v177, v161
    v_mul_f32 v178, v178, v162
    v_mul_f32 v179, v179, v163
    v_mul_f32 v180, v180, v164
    v_mul_f32 v181, v181, v165
    v_mul_f32 v182, v182, v166
    v_mul_f32 v183, v183, v167
    v_cvt_pk_bf16_f32 v152, v152, v153
    v_cvt_pk_bf16_f32 v153, v154, v155
    v_cvt_pk_bf16_f32 v154, v156, v157
    v_cvt_pk_bf16_f32 v155, v158, v159
    v_cvt_pk_bf16_f32 v156, v160, v161
    v_cvt_pk_bf16_f32 v157, v162, v163
    v_cvt_pk_bf16_f32 v158, v164, v165
    v_cvt_pk_bf16_f32 v159, v166, v167
    v_cvt_pk_bf16_f32 v168, v168, v169
    v_cvt_pk_bf16_f32 v169, v170, v171
    v_cvt_pk_bf16_f32 v170, v172, v173
    v_cvt_pk_bf16_f32 v171, v174, v175
    v_cvt_pk_bf16_f32 v172, v176, v177
    v_cvt_pk_bf16_f32 v173, v178, v179
    v_cvt_pk_bf16_f32 v174, v180, v181
    v_cvt_pk_bf16_f32 v175, v182, v183
    v_mfma_f32_32x32x16_bf16 v[88:103], v[200:203], v[152:155], v[88:103]
    v_exp_f32 v184, v184
    v_exp_f32 v185, v185
    v_exp_f32 v186, v186
    v_exp_f32 v187, v187
    v_exp_f32 v188, v188
    v_exp_f32 v189, v189
    v_mfma_f32_32x32x16_bf16 v[120:135], v[200:203], v[168:171], v[120:135]
    v_exp_f32 v190, v190
    v_exp_f32 v191, v191
    v_exp_f32 v192, v192
    v_exp_f32 v193, v193
    v_exp_f32 v194, v194
    v_exp_f32 v195, v195
    v_mfma_f32_32x32x16_bf16 v[88:103], v[204:207], v[156:159], v[88:103]
    v_exp_f32 v196, v196
    v_exp_f32 v197, v197
    v_exp_f32 v198, v198
    v_exp_f32 v199, v199
    v_add_f32 v184, 1.0, v184
    v_add_f32 v185, 1.0, v185
    v_mfma_f32_32x32x16_bf16 v[120:135], v[204:207], v[172:175], v[120:135]
    v_add_f32 v186, 1.0, v186
    v_add_f32 v187, 1.0, v187
    v_add_f32 v188, 1.0, v188
    v_add_f32 v189, 1.0, v189
    v_add_f32 v190, 1.0, v190
    v_add_f32 v191, 1.0, v191
    v_mfma_f32_32x32x16_bf16 v[168:183], v[228:231], v[52:55], 0
    v_add_f32 v192, 1.0, v192
    v_add_f32 v193, 1.0, v193
    v_add_f32 v194, 1.0, v194
    v_add_f32 v195, 1.0, v195
    v_add_f32 v196, 1.0, v196
    v_add_f32 v197, 1.0, v197
    v_mfma_f32_32x32x16_bf16 v[168:183], v[232:235], v[60:63], v[168:183]
    v_add_f32 v198, 1.0, v198
    v_add_f32 v199, 1.0, v199
    v_rcp_f32 v184, v184
    v_rcp_f32 v185, v185
    v_rcp_f32 v186, v186
    v_rcp_f32 v187, v187
    v_mfma_f32_32x32x16_bf16 v[168:183], v[236:239], v[68:71], v[168:183]
    v_rcp_f32 v188, v188
    v_rcp_f32 v189, v189
    v_rcp_f32 v190, v190
    v_rcp_f32 v191, v191
    v_rcp_f32 v192, v192
    v_rcp_f32 v193, v193
    v_mfma_f32_32x32x16_bf16 v[168:183], v[240:243], v[76:79], v[168:183]
    v_rcp_f32 v194, v194
    v_rcp_f32 v195, v195
    v_rcp_f32 v196, v196
    v_rcp_f32 v197, v197
    v_rcp_f32 v198, v198
    v_rcp_f32 v199, v199
    s_nop 5
    v_mul_f32 v168, v168, v184
    v_mul_f32 v169, v169, v185
    v_mul_f32 v170, v170, v186
    v_mul_f32 v171, v171, v187
    v_mul_f32 v172, v172, v188
    v_mul_f32 v173, v173, v189
    v_mul_f32 v174, v174, v190
    v_mul_f32 v175, v175, v191
    v_mul_f32 v176, v176, v192
    v_mul_f32 v177, v177, v193
    v_mul_f32 v178, v178, v194
    v_mul_f32 v179, v179, v195
    v_mul_f32 v180, v180, v196
    v_mul_f32 v181, v181, v197
    v_mul_f32 v182, v182, v198
    v_mul_f32 v183, v183, v199
    v_cvt_pk_bf16_f32 v184, v184, v185
    v_cvt_pk_bf16_f32 v185, v186, v187
    v_cvt_pk_bf16_f32 v186, v188, v189
    v_cvt_pk_bf16_f32 v187, v190, v191
    v_cvt_pk_bf16_f32 v188, v192, v193
    v_cvt_pk_bf16_f32 v189, v194, v195
    v_cvt_pk_bf16_f32 v190, v196, v197
    v_cvt_pk_bf16_f32 v191, v198, v199
    v_cvt_pk_bf16_f32 v168, v168, v169
    v_cvt_pk_bf16_f32 v169, v170, v171
    v_cvt_pk_bf16_f32 v170, v172, v173
    v_cvt_pk_bf16_f32 v171, v174, v175
    v_cvt_pk_bf16_f32 v172, v176, v177
    v_cvt_pk_bf16_f32 v173, v178, v179
    v_cvt_pk_bf16_f32 v174, v180, v181
    v_cvt_pk_bf16_f32 v175, v182, v183
    v_mfma_f32_32x32x16_bf16 v[104:119], v[200:203], v[184:187], v[104:119]
    v_mfma_f32_32x32x16_bf16 v[136:151], v[200:203], v[168:171], v[136:151]
    v_mfma_f32_32x32x16_bf16 v[104:119], v[204:207], v[188:191], v[104:119]
    v_mfma_f32_32x32x16_bf16 v[136:151], v[204:207], v[172:175], v[136:151]
    s_sub_u32 s42, s42, 1
    s_cmp_eq_u32 s42, 0
    s_nop 9
    s_cbranch_scc1 LOOP_DONE
    ds_read_b64 v[12:13], v8 offset:8448
    ds_read_b128 v[168:171], v9 offset:13312
    ds_read_b128 v[172:175], v9 offset:13344
    ds_read_b128 v[176:179], v9 offset:13376
    ds_read_b128 v[180:183], v9 offset:13408
    ds_read_b64 v[200:201], v10 offset:15872
    ds_read_b64 v[202:203], v10 offset:15888
    ds_read_b64 v[204:205], v10 offset:15904
    ds_read_b64 v[206:207], v10 offset:15920
    s_waitcnt lgkmcnt(8)
    v_and_or_b32 v12, v12, v248, v4
    v_and_or_b32 v13, v13, v249, v5
    buffer_load_dwordx4 v[228:231], v12, s[8:11], 0 offen offset:0
    buffer_load_dwordx4 v[232:235], v12, s[8:11], 0 offen offset:16
    buffer_load_dwordx4 v[236:239], v12, s[8:11], 0 offen offset:32
    buffer_load_dwordx4 v[240:243], v12, s[8:11], 0 offen offset:48
    buffer_load_dwordx4 v[244:247], v13, s[12:15], 0 offen nt
    s_waitcnt lgkmcnt(4)
    v_add_u32 v168, v168, v6
    v_add_u32 v169, v169, v6
    v_add_u32 v170, v170, v6
    v_add_u32 v171, v171, v6
    v_add_u32 v172, v172, v6
    v_add_u32 v173, v173, v6
    v_add_u32 v174, v174, v6
    v_add_u32 v175, v175, v6
    v_add_u32 v176, v176, v6
    v_add_u32 v177, v177, v6
    v_add_u32 v178, v178, v6
    v_add_u32 v179, v179, v6
    v_add_u32 v180, v180, v6
    v_add_u32 v181, v181, v6
    v_add_u32 v182, v182, v6
    v_add_u32 v183, v183, v6
    ds_read_b32 v152, v168 offset:0
    ds_read_b32 v153, v169 offset:0
    ds_read_b32 v154, v170 offset:0
    ds_read_b32 v155, v171 offset:0
    ds_read_b32 v156, v172 offset:0
    ds_read_b32 v157, v173 offset:0
    ds_read_b32 v158, v174 offset:0
    ds_read_b32 v159, v175 offset:0
    ds_read_b32 v160, v176 offset:0
    ds_read_b32 v161, v177 offset:0
    ds_read_b32 v162, v178 offset:0
    ds_read_b32 v163, v179 offset:0
    ds_read_b32 v164, v180 offset:0
    ds_read_b32 v165, v181 offset:0
    ds_read_b32 v166, v182 offset:0
    ds_read_b32 v167, v183 offset:0
    ds_read_b32 v184, v168 offset:128
    ds_read_b32 v185, v169 offset:128
    ds_read_b32 v186, v170 offset:128
    ds_read_b32 v187, v171 offset:128
    ds_read_b32 v188, v172 offset:128
    ds_read_b32 v189, v173 offset:128
    ds_read_b32 v190, v174 offset:128
    ds_read_b32 v191, v175 offset:128
    ds_read_b32 v192, v176 offset:128
    ds_read_b32 v193, v177 offset:128
    ds_read_b32 v194, v178 offset:128
    ds_read_b32 v195, v179 offset:128
    ds_read_b32 v196, v180 offset:128
    ds_read_b32 v197, v181 offset:128
    ds_read_b32 v198, v182 offset:128
    ds_read_b32 v199, v183 offset:128
    s_waitcnt vmcnt(5) lgkmcnt(15)
    v_mfma_f32_32x32x16_bf16 v[152:167], v[208:211], v[16:19], v[152:167]
    v_lshrrev_b32 v200, v7, v200
    v_lshrrev_b32 v201, v7, v201
    v_lshrrev_b32 v202, v7, v202
    v_lshrrev_b32 v203, v7, v203
    v_lshrrev_b32 v204, v7, v204
    v_mfma_f32_32x32x16_bf16 v[152:167], v[212:215], v[24:27], v[152:167]
    v_lshrrev_b32 v205, v7, v205
    v_lshrrev_b32 v206, v7, v206
    v_lshrrev_b32 v207, v7, v207
    v_and_b32 v200, v14, v200
    v_and_b32 v201, v14, v201
    v_mfma_f32_32x32x16_bf16 v[152:167], v[216:219], v[32:35], v[152:167]
    v_and_b32 v202, v14, v202
    v_and_b32 v203, v14, v203
    v_and_b32 v204, v14, v204
    v_and_b32 v205, v14, v205
    v_and_b32 v206, v14, v206
    v_and_b32 v207, v14, v207
    v_mfma_f32_32x32x16_bf16 v[152:167], v[220:223], v[40:43], v[152:167]
    v_mul_u32_u24 v200, v15, v200
    v_mul_u32_u24 v201, v15, v201
    v_mul_u32_u24 v202, v15, v202
    v_mul_u32_u24 v203, v15, v203
    v_mul_u32_u24 v204, v15, v204
    v_mfma_f32_32x32x16_bf16 v[152:167], v[224:227], v[80:83], v[152:167]
    v_mul_u32_u24 v205, v15, v205
    v_mul_u32_u24 v206, v15, v206
    v_mul_u32_u24 v207, v15, v207
    v_add_u32 v8, 256, v8
    v_add_u32 v9, 128, v9
    v_add_u32 v10, 64, v10
    s_waitcnt lgkmcnt(0)
    v_mfma_f32_32x32x16_bf16 v[168:183], v[208:211], v[48:51], 0
    s_nop 3
    v_exp_f32 v152, v152
    v_exp_f32 v153, v153
    v_exp_f32 v154, v154
    v_exp_f32 v155, v155
    v_exp_f32 v156, v156
    v_mfma_f32_32x32x16_bf16 v[168:183], v[212:215], v[56:59], v[168:183]
    v_exp_f32 v157, v157
    v_exp_f32 v158, v158
    v_exp_f32 v159, v159
    v_exp_f32 v160, v160
    v_exp_f32 v161, v161
    v_mfma_f32_32x32x16_bf16 v[168:183], v[216:219], v[64:67], v[168:183]
    v_exp_f32 v162, v162
    v_exp_f32 v163, v163
    v_exp_f32 v164, v164
    v_exp_f32 v165, v165
    v_exp_f32 v166, v166
    v_exp_f32 v167, v167
    v_mfma_f32_32x32x16_bf16 v[168:183], v[220:223], v[72:75], v[168:183]
    v_add_f32 v152, 1.0, v152
    v_add_f32 v153, 1.0, v153
    v_add_f32 v154, 1.0, v154
    v_add_f32 v155, 1.0, v155
    v_add_f32 v156, 1.0, v156
    v_mfma_f32_32x32x16_bf16 v[184:199], v[208:211], v[20:23], v[184:199]
    v_add_f32 v157, 1.0, v157
    v_add_f32 v158, 1.0, v158
    v_add_f32 v159, 1.0, v159
    v_add_f32 v160, 1.0, v160
    v_add_f32 v161, 1.0, v161
    v_mfma_f32_32x32x16_bf16 v[184:199], v[212:215], v[28:31], v[184:199]
    v_add_f32 v162, 1.0, v162
    v_add_f32 v163, 1.0, v163
    v_add_f32 v164, 1.0, v164
    v_add_f32 v165, 1.0, v165
    v_add_f32 v166, 1.0, v166
    v_add_f32 v167, 1.0, v167
    v_mfma_f32_32x32x16_bf16 v[184:199], v[216:219], v[36:39], v[184:199]
    v_rcp_f32 v152, v152
    v_rcp_f32 v153, v153
    v_rcp_f32 v154, v154
    v_rcp_f32 v155, v155
    v_rcp_f32 v156, v156
    v_mfma_f32_32x32x16_bf16 v[184:199], v[220:223], v[44:47], v[184:199]
    v_rcp_f32 v157, v157
    v_rcp_f32 v158, v158
    v_rcp_f32 v159, v159
    v_rcp_f32 v160, v160
    v_rcp_f32 v161, v161
    v_mfma_f32_32x32x16_bf16 v[184:199], v[224:227], v[84:87], v[184:199]
    v_rcp_f32 v162, v162
    v_rcp_f32 v163, v163
    v_rcp_f32 v164, v164
    v_rcp_f32 v165, v165
    v_rcp_f32 v166, v166
    v_rcp_f32 v167, v167
    v_mul_f32 v168, v168, v152
    v_mul_f32 v169, v169, v153
    v_mul_f32 v170, v170, v154
    v_mul_f32 v171, v171, v155
    v_mul_f32 v172, v172, v156
    v_mul_f32 v173, v173, v157
    v_mul_f32 v174, v174, v158
    v_mul_f32 v175, v175, v159
    v_mul_f32 v176, v176, v160
    v_mul_f32 v177, v177, v161
    v_mul_f32 v178, v178, v162
    v_mul_f32 v179, v179, v163
    v_mul_f32 v180, v180, v164
    v_mul_f32 v181, v181, v165
    v_mul_f32 v182, v182, v166
    v_mul_f32 v183, v183, v167
    v_cvt_pk_bf16_f32 v152, v152, v153
    v_cvt_pk_bf16_f32 v153, v154, v155
    v_cvt_pk_bf16_f32 v154, v156, v157
    v_cvt_pk_bf16_f32 v155, v158, v159
    v_cvt_pk_bf16_f32 v156, v160, v161
    v_cvt_pk_bf16_f32 v157, v162, v163
    v_cvt_pk_bf16_f32 v158, v164, v165
    v_cvt_pk_bf16_f32 v159, v166, v167
    v_cvt_pk_bf16_f32 v168, v168, v169
    v_cvt_pk_bf16_f32 v169, v170, v171
    v_cvt_pk_bf16_f32 v170, v172, v173
    v_cvt_pk_bf16_f32 v171, v174, v175
    v_cvt_pk_bf16_f32 v172, v176, v177
    v_cvt_pk_bf16_f32 v173, v178, v179
    v_cvt_pk_bf16_f32 v174, v180, v181
    v_cvt_pk_bf16_f32 v175, v182, v183
    v_mfma_f32_32x32x16_bf16 v[88:103], v[200:203], v[152:155], v[88:103]
    v_exp_f32 v184, v184
    v_exp_f32 v185, v185
    v_exp_f32 v186, v186
    v_exp_f32 v187, v187
    v_exp_f32 v188, v188
    v_exp_f32 v189, v189
    v_mfma_f32_32x32x16_bf16 v[120:135], v[200:203], v[168:171], v[120:135]
    v_exp_f32 v190, v190
    v_exp_f32 v191, v191
    v_exp_f32 v192, v192
    v_exp_f32 v193, v193
    v_exp_f32 v194, v194
    v_exp_f32 v195, v195
    v_mfma_f32_32x32x16_bf16 v[88:103], v[204:207], v[156:159], v[88:103]
    v_exp_f32 v196, v196
    v_exp_f32 v197, v197
    v_exp_f32 v198, v198
    v_exp_f32 v199, v199
    v_add_f32 v184, 1.0, v184
    v_add_f32 v185, 1.0, v185
    v_mfma_f32_32x32x16_bf16 v[120:135], v[204:207], v[172:175], v[120:135]
    v_add_f32 v186, 1.0, v186
    v_add_f32 v187, 1.0, v187
    v_add_f32 v188, 1.0, v188
    v_add_f32 v189, 1.0, v189
    v_add_f32 v190, 1.0, v190
    v_add_f32 v191, 1.0, v191
    v_mfma_f32_32x32x16_bf16 v[168:183], v[208:211], v[52:55], 0
    v_add_f32 v192, 1.0, v192
    v_add_f32 v193, 1.0, v193
    v_add_f32 v194, 1.0, v194
    v_add_f32 v195, 1.0, v195
    v_add_f32 v196, 1.0, v196
    v_add_f32 v197, 1.0, v197
    v_mfma_f32_32x32x16_bf16 v[168:183], v[212:215], v[60:63], v[168:183]
    v_add_f32 v198, 1.0, v198
    v_add_f32 v199, 1.0, v199
    v_rcp_f32 v184, v184
    v_rcp_f32 v185, v185
    v_rcp_f32 v186, v186
    v_rcp_f32 v187, v187
    v_mfma_f32_32x32x16_bf16 v[168:183], v[216:219], v[68:71], v[168:183]
    v_rcp_f32 v188, v188
    v_rcp_f32 v189, v189
    v_rcp_f32 v190, v190
    v_rcp_f32 v191, v191
    v_rcp_f32 v192, v192
    v_rcp_f32 v193, v193
    v_mfma_f32_32x32x16_bf16 v[168:183], v[220:223], v[76:79], v[168:183]
    v_rcp_f32 v194, v194
    v_rcp_f32 v195, v195
    v_rcp_f32 v196, v196
    v_rcp_f32 v197, v197
    v_rcp_f32 v198, v198
    v_rcp_f32 v199, v199
    s_nop 5
    v_mul_f32 v168, v168, v184
    v_mul_f32 v169, v169, v185
    v_mul_f32 v170, v170, v186
    v_mul_f32 v171, v171, v187
    v_mul_f32 v172, v172, v188
    v_mul_f32 v173, v173, v189
    v_mul_f32 v174, v174, v190
    v_mul_f32 v175, v175, v191
    v_mul_f32 v176, v176, v192
    v_mul_f32 v177, v177, v193
    v_mul_f32 v178, v178, v194
    v_mul_f32 v179, v179, v195
    v_mul_f32 v180, v180, v196
    v_mul_f32 v181, v181, v197
    v_mul_f32 v182, v182, v198
    v_mul_f32 v183, v183, v199
    v_cvt_pk_bf16_f32 v184, v184, v185
    v_cvt_pk_bf16_f32 v185, v186, v187
    v_cvt_pk_bf16_f32 v186, v188, v189
    v_cvt_pk_bf16_f32 v187, v190, v191
    v_cvt_pk_bf16_f32 v188, v192, v193
    v_cvt_pk_bf16_f32 v189, v194, v195
    v_cvt_pk_bf16_f32 v190, v196, v197
    v_cvt_pk_bf16_f32 v191, v198, v199
    v_cvt_pk_bf16_f32 v168, v168, v169
    v_cvt_pk_bf16_f32 v169, v170, v171
    v_cvt_pk_bf16_f32 v170, v172, v173
    v_cvt_pk_bf16_f32 v171, v174, v175
    v_cvt_pk_bf16_f32 v172, v176, v177
    v_cvt_pk_bf16_f32 v173, v178, v179
    v_cvt_pk_bf16_f32 v174, v180, v181
    v_cvt_pk_bf16_f32 v175, v182, v183
    v_mfma_f32_32x32x16_bf16 v[104:119], v[200:203], v[184:187], v[104:119]
    v_mfma_f32_32x32x16_bf16 v[136:151], v[200:203], v[168:171], v[136:151]
    v_mfma_f32_32x32x16_bf16 v[104:119], v[204:207], v[188:191], v[104:119]
    v_mfma_f32_32x32x16_bf16 v[136:151], v[204:207], v[172:175], v[136:151]
    s_sub_u32 s42, s42, 1
    s_cmp_eq_u32 s42, 0
    s_nop 9
    s_cbranch_scc0 LOOP
LOOP_DONE:
    s_waitcnt vmcnt(0) lgkmcnt(0)
    s_add_u32 s41, s41, 512
    s_cmp_ge_u32 s41, s47
    s_cbranch_scc1 EPILOGUE
    s_barrier
    v_lshrrev_b32 v242, 3, v0
    v_lshlrev_b32 v242, 8, v242
    v_and_b32 v243, 7, v0
    v_lshl_add_u32 v242, v243, 4, v242
    s_mul_i32 s45, s2, 64000
    s_add_u32 s45, s45, 0
    buffer_load_dwordx4 v[208:211], v242, s[56:59], s45 offen
    s_mul_i32 s45, s2, 64000
    s_add_u32 s45, s45, 16384
    buffer_load_dwordx4 v[212:215], v242, s[56:59], s45 offen
    s_mul_i32 s45, s2, 64000
    s_add_u32 s45, s45, 32768
    buffer_load_dwordx4 v[216:219], v242, s[56:59], s45 offen
    s_mul_i32 s45, s2, 64000
    s_add_u32 s45, s45, 49152
    buffer_load_dwordx4 v[220:223], v242, s[56:59], s45 offen
    s_waitcnt vmcnt(0)
    s_branch ROUND
EPILOGUE:
    s_waitcnt vmcnt(0) lgkmcnt(0)
    v_lshlrev_b32 v242, 4, v1
    s_mov_b32 s45, 32768
    buffer_load_dwordx4 v[16:19], v242, s[16:19], s45 offen offset:0
    buffer_load_dwordx4 v[20:23], v242, s[16:19], s45 offen offset:1024
    buffer_load_dwordx4 v[24:27], v242, s[16:19], s45 offen offset:2048
    buffer_load_dwordx4 v[28:31], v242, s[16:19], s45 offen offset:3072
    s_mov_b32 s45, 36864
    buffer_load_dwordx4 v[32:35], v242, s[16:19], s45 offen offset:0
    buffer_load_dwordx4 v[36:39], v242, s[16:19], s45 offen offset:1024
    buffer_load_dwordx4 v[40:43], v242, s[16:19], s45 offen offset:2048
    buffer_load_dwordx4 v[44:47], v242, s[16:19], s45 offen offset:3072
    v_add_u32 v241, s38, v2
    v_lshl_add_u32 v241, v241, 7, v4
    buffer_load_dwordx4 v[208:211], v241, s[8:11], 0 offen offset:0
    buffer_load_dwordx4 v[212:215], v241, s[8:11], 0 offen offset:16
    buffer_load_dwordx4 v[216:219], v241, s[8:11], 0 offen offset:32
    buffer_load_dwordx4 v[220:223], v241, s[8:11], 0 offen offset:48
    v_lshl_add_u32 v240, v3, 2, s38
    v_lshlrev_b32 v240, 7, v240
    v_lshl_add_u32 v240, v2, 2, v240
    buffer_load_dword v48, v240, s[8:11], 0 offen offset:0
    buffer_load_dword v49, v240, s[8:11], 0 offen offset:128
    buffer_load_dword v50, v240, s[8:11], 0 offen offset:256
    buffer_load_dword v51, v240, s[8:11], 0 offen offset:384
    buffer_load_dword v52, v240, s[8:11], 0 offen offset:1024
    buffer_load_dword v53, v240, s[8:11], 0 offen offset:1152
    buffer_load_dword v54, v240, s[8:11], 0 offen offset:1280
    buffer_load_dword v55, v240, s[8:11], 0 offen offset:1408
    buffer_load_dword v56, v240, s[8:11], 0 offen offset:2048
    buffer_load_dword v57, v240, s[8:11], 0 offen offset:2176
    buffer_load_dword v58, v240, s[8:11], 0 offen offset:2304
    buffer_load_dword v59, v240, s[8:11], 0 offen offset:2432
    buffer_load_dword v60, v240, s[8:11], 0 offen offset:3072
    buffer_load_dword v61, v240, s[8:11], 0 offen offset:3200
    buffer_load_dword v62, v240, s[8:11], 0 offen offset:3328
    buffer_load_dword v63, v240, s[8:11], 0 offen offset:3456
    v_mov_b32 v243, 1073741824
    v_lshlrev_b32 v241, 2, v3
    v_cmp_gt_u32 vcc, 25, v241
    v_add_u32 v64, 0, v240
    s_nop 0
    v_cndmask_b32 v64, v243, v64, vcc
    v_cmp_gt_u32 vcc, 24, v241
    v_add_u32 v65, 128, v240
    s_nop 0
    v_cndmask_b32 v65, v243, v65, vcc
    v_cmp_gt_u32 vcc, 23, v241
    v_add_u32 v66, 256, v240
    s_nop 0
    v_cndmask_b32 v66, v243, v66, vcc
    v_cmp_gt_u32 vcc, 22, v241
    v_add_u32 v67, 384, v240
    s_nop 0
    v_cndmask_b32 v67, v243, v67, vcc
    v_cmp_gt_u32 vcc, 17, v241
    v_add_u32 v68, 1024, v240
    s_nop 0
    v_cndmask_b32 v68, v243, v68, vcc
    v_cmp_gt_u32 vcc, 16, v241
    v_add_u32 v69, 1152, v240
    s_nop 0
    v_cndmask_b32 v69, v243, v69, vcc
    v_cmp_gt_u32 vcc, 15, v241
    v_add_u32 v70, 1280, v240
    s_nop 0
    v_cndmask_b32 v70, v243, v70, vcc
    v_cmp_gt_u32 vcc, 14, v241
    v_add_u32 v71, 1408, v240
    s_nop 0
    v_cndmask_b32 v71, v243, v71, vcc
    v_cmp_gt_u32 vcc, 9, v241
    v_add_u32 v72, 2048, v240
    s_nop 0
    v_cndmask_b32 v72, v243, v72, vcc
    v_cmp_gt_u32 vcc, 8, v241
    v_add_u32 v73, 2176, v240
    s_nop 0
    v_cndmask_b32 v73, v243, v73, vcc
    v_cmp_gt_u32 vcc, 7, v241
    v_add_u32 v74, 2304, v240
    s_nop 0
    v_cndmask_b32 v74, v243, v74, vcc
    v_cmp_gt_u32 vcc, 6, v241
    v_add_u32 v75, 2432, v240
    s_nop 0
    v_cndmask_b32 v75, v243, v75, vcc
    v_cmp_gt_u32 vcc, 1, v241
    v_add_u32 v76, 3072, v240
    s_nop 0
    v_cndmask_b32 v76, v243, v76, vcc
    v_cmp_gt_u32 vcc, 0, v241
    v_add_u32 v77, 3200, v240
    s_nop 0
    v_cndmask_b32 v77, v243, v77, vcc
    v_cmp_gt_u32 vcc, 0, v241
    v_add_u32 v78, 3328, v240
    s_nop 0
    v_cndmask_b32 v78, v243, v78, vcc
    v_cmp_gt_u32 vcc, 0, v241
    v_add_u32 v79, 3456, v240
    s_nop 0
    v_cndmask_b32 v79, v243, v79, vcc
    v_mov_b32 v243, 0x358637bd
    v_add_f32 v88, v243, v88
    v_add_f32 v89, v243, v89
    v_add_f32 v90, v243, v90
    v_add_f32 v91, v243, v91
    v_add_f32 v92, v243, v92
    v_add_f32 v93, v243, v93
    v_add_f32 v94, v243, v94
    v_add_f32 v95, v243, v95
    v_add_f32 v96, v243, v96
    v_add_f32 v97, v243, v97
    v_add_f32 v98, v243, v98
    v_add_f32 v99, v243, v99
    v_add_f32 v100, v243, v100
    v_add_f32 v101, v243, v101
    v_add_f32 v102, v243, v102
    v_add_f32 v103, v243, v103
    v_add_f32 v104, v243, v104
    v_add_f32 v105, v243, v105
    v_add_f32 v106, v243, v106
    v_add_f32 v107, v243, v107
    v_add_f32 v108, v243, v108
    v_add_f32 v109, v243, v109
    v_add_f32 v110, v243, v110
    v_add_f32 v111, v243, v111
    v_add_f32 v112, v243, v112
    v_add_f32 v113, v243, v113
    v_add_f32 v114, v243, v114
    v_add_f32 v115, v243, v115
    v_add_f32 v116, v243, v116
    v_add_f32 v117, v243, v117
    v_add_f32 v118, v243, v118
    v_add_f32 v119, v243, v119
    v_rcp_f32 v88, v88
    v_rcp_f32 v89, v89
    v_rcp_f32 v90, v90
    v_rcp_f32 v91, v91
    v_rcp_f32 v92, v92
    v_rcp_f32 v93, v93
    v_rcp_f32 v94, v94
    v_rcp_f32 v95, v95
    v_rcp_f32 v96, v96
    v_rcp_f32 v97, v97
    v_rcp_f32 v98, v98
    v_rcp_f32 v99, v99
    v_rcp_f32 v100, v100
    v_rcp_f32 v101, v101
    v_rcp_f32 v102, v102
    v_rcp_f32 v103, v103
    v_rcp_f32 v104, v104
    v_rcp_f32 v105, v105
    v_rcp_f32 v106, v106
    v_rcp_f32 v107, v107
    v_rcp_f32 v108, v108
    v_rcp_f32 v109, v109
    v_rcp_f32 v110, v110
    v_rcp_f32 v111, v111
    v_rcp_f32 v112, v112
    v_rcp_f32 v113, v113
    v_rcp_f32 v114, v114
    v_rcp_f32 v115, v115
    v_rcp_f32 v116, v116
    v_rcp_f32 v117, v117
    v_rcp_f32 v118, v118
    v_rcp_f32 v119, v119
    s_waitcnt vmcnt(16)
    v_mfma_f32_32x32x16_bf16 v[152:167], v[208:211], v[16:19], 0
    v_mfma_f32_32x32x16_bf16 v[152:167], v[212:215], v[24:27], v[152:167]
    v_mfma_f32_32x32x16_bf16 v[152:167], v[216:219], v[32:35], v[152:167]
    v_mfma_f32_32x32x16_bf16 v[152:167], v[220:223], v[40:43], v[152:167]
    v_mfma_f32_32x32x16_bf16 v[168:183], v[208:211], v[20:23], 0
    v_mfma_f32_32x32x16_bf16 v[168:183], v[212:215], v[28:31], v[168:183]
    v_mfma_f32_32x32x16_bf16 v[168:183], v[216:219], v[36:39], v[168:183]
    v_mfma_f32_32x32x16_bf16 v[168:183], v[220:223], v[44:47], v[168:183]
    s_nop 7
    v_fma_f32 v152, v120, v88, v152
    v_fma_f32 v153, v121, v89, v153
    v_fma_f32 v154, v122, v90, v154
    v_fma_f32 v155, v123, v91, v155
    v_fma_f32 v156, v124, v92, v156
    v_fma_f32 v157, v125, v93, v157
    v_fma_f32 v158, v126, v94, v158
    v_fma_f32 v159, v127, v95, v159
    v_fma_f32 v160, v128, v96, v160
    v_fma_f32 v161, v129, v97, v161
    v_fma_f32 v162, v130, v98, v162
    v_fma_f32 v163, v131, v99, v163
    v_fma_f32 v164, v132, v100, v164
    v_fma_f32 v165, v133, v101, v165
    v_fma_f32 v166, v134, v102, v166
    v_fma_f32 v167, v135, v103, v167
    v_max_f32 v152, 0, v152
    v_max_f32 v153, 0, v153
    v_max_f32 v154, 0, v154
    v_max_f32 v155, 0, v155
    v_max_f32 v156, 0, v156
    v_max_f32 v157, 0, v157
    v_max_f32 v158, 0, v158
    v_max_f32 v159, 0, v159
    v_max_f32 v160, 0, v160
    v_max_f32 v161, 0, v161
    v_max_f32 v162, 0, v162
    v_max_f32 v163, 0, v163
    v_max_f32 v164, 0, v164
    v_max_f32 v165, 0, v165
    v_max_f32 v166, 0, v166
    v_max_f32 v167, 0, v167
    v_fma_f32 v168, v136, v104, v168
    v_fma_f32 v169, v137, v105, v169
    v_fma_f32 v170, v138, v106, v170
    v_fma_f32 v171, v139, v107, v171
    v_fma_f32 v172, v140, v108, v172
    v_fma_f32 v173, v141, v109, v173
    v_fma_f32 v174, v142, v110, v174
    v_fma_f32 v175, v143, v111, v175
    v_fma_f32 v176, v144, v112, v176
    v_fma_f32 v177, v145, v113, v177
    v_fma_f32 v178, v146, v114, v178
    v_fma_f32 v179, v147, v115, v179
    v_fma_f32 v180, v148, v116, v180
    v_fma_f32 v181, v149, v117, v181
    v_fma_f32 v182, v150, v118, v182
    v_fma_f32 v183, v151, v119, v183
    v_max_f32 v168, 0, v168
    v_max_f32 v169, 0, v169
    v_max_f32 v170, 0, v170
    v_max_f32 v171, 0, v171
    v_max_f32 v172, 0, v172
    v_max_f32 v173, 0, v173
    v_max_f32 v174, 0, v174
    v_max_f32 v175, 0, v175
    v_max_f32 v176, 0, v176
    v_max_f32 v177, 0, v177
    v_max_f32 v178, 0, v178
    v_max_f32 v179, 0, v179
    v_max_f32 v180, 0, v180
    v_max_f32 v181, 0, v181
    v_max_f32 v182, 0, v182
    v_max_f32 v183, 0, v183
    s_waitcnt vmcnt(0)
    v_lshlrev_b32 v184, 16, v48
    v_and_b32 v185, 0xffff0000, v48
    v_add_f32 v184, v184, v152
    v_add_f32 v185, v185, v168
    v_cvt_pk_bf16_f32 v48, v184, v185
    buffer_store_dword v48, v64, s[28:31], 0 offen
    v_lshlrev_b32 v184, 16, v49
    v_and_b32 v185, 0xffff0000, v49
    v_add_f32 v184, v184, v153
    v_add_f32 v185, v185, v169
    v_cvt_pk_bf16_f32 v49, v184, v185
    buffer_store_dword v49, v65, s[28:31], 0 offen
    v_lshlrev_b32 v184, 16, v50
    v_and_b32 v185, 0xffff0000, v50
    v_add_f32 v184, v184, v154
    v_add_f32 v185, v185, v170
    v_cvt_pk_bf16_f32 v50, v184, v185
    buffer_store_dword v50, v66, s[28:31], 0 offen
    v_lshlrev_b32 v184, 16, v51
    v_and_b32 v185, 0xffff0000, v51
    v_add_f32 v184, v184, v155
    v_add_f32 v185, v185, v171
    v_cvt_pk_bf16_f32 v51, v184, v185
    buffer_store_dword v51, v67, s[28:31], 0 offen
    v_lshlrev_b32 v184, 16, v52
    v_and_b32 v185, 0xffff0000, v52
    v_add_f32 v184, v184, v156
    v_add_f32 v185, v185, v172
    v_cvt_pk_bf16_f32 v52, v184, v185
    buffer_store_dword v52, v68, s[28:31], 0 offen
    v_lshlrev_b32 v184, 16, v53
    v_and_b32 v185, 0xffff0000, v53
    v_add_f32 v184, v184, v157
    v_add_f32 v185, v185, v173
    v_cvt_pk_bf16_f32 v53, v184, v185
    buffer_store_dword v53, v69, s[28:31], 0 offen
    v_lshlrev_b32 v184, 16, v54
    v_and_b32 v185, 0xffff0000, v54
    v_add_f32 v184, v184, v158
    v_add_f32 v185, v185, v174
    v_cvt_pk_bf16_f32 v54, v184, v185
    buffer_store_dword v54, v70, s[28:31], 0 offen
    v_lshlrev_b32 v184, 16, v55
    v_and_b32 v185, 0xffff0000, v55
    v_add_f32 v184, v184, v159
    v_add_f32 v185, v185, v175
    v_cvt_pk_bf16_f32 v55, v184, v185
    buffer_store_dword v55, v71, s[28:31], 0 offen
    v_lshlrev_b32 v184, 16, v56
    v_and_b32 v185, 0xffff0000, v56
    v_add_f32 v184, v184, v160
    v_add_f32 v185, v185, v176
    v_cvt_pk_bf16_f32 v56, v184, v185
    buffer_store_dword v56, v72, s[28:31], 0 offen
    v_lshlrev_b32 v184, 16, v57
    v_and_b32 v185, 0xffff0000, v57
    v_add_f32 v184, v184, v161
    v_add_f32 v185, v185, v177
    v_cvt_pk_bf16_f32 v57, v184, v185
    buffer_store_dword v57, v73, s[28:31], 0 offen
    v_lshlrev_b32 v184, 16, v58
    v_and_b32 v185, 0xffff0000, v58
    v_add_f32 v184, v184, v162
    v_add_f32 v185, v185, v178
    v_cvt_pk_bf16_f32 v58, v184, v185
    buffer_store_dword v58, v74, s[28:31], 0 offen
    v_lshlrev_b32 v184, 16, v59
    v_and_b32 v185, 0xffff0000, v59
    v_add_f32 v184, v184, v163
    v_add_f32 v185, v185, v179
    v_cvt_pk_bf16_f32 v59, v184, v185
    buffer_store_dword v59, v75, s[28:31], 0 offen
    v_lshlrev_b32 v184, 16, v60
    v_and_b32 v185, 0xffff0000, v60
    v_add_f32 v184, v184, v164
    v_add_f32 v185, v185, v180
    v_cvt_pk_bf16_f32 v60, v184, v185
    buffer_store_dword v60, v76, s[28:31], 0 offen
    v_lshlrev_b32 v184, 16, v61
    v_and_b32 v185, 0xffff0000, v61
    v_add_f32 v184, v184, v165
    v_add_f32 v185, v185, v181
    v_cvt_pk_bf16_f32 v61, v184, v185
    buffer_store_dword v61, v77, s[28:31], 0 offen
    v_lshlrev_b32 v184, 16, v62
    v_and_b32 v185, 0xffff0000, v62
    v_add_f32 v184, v184, v166
    v_add_f32 v185, v185, v182
    v_cvt_pk_bf16_f32 v62, v184, v185
    buffer_store_dword v62, v78, s[28:31], 0 offen
    v_lshlrev_b32 v184, 16, v63
    v_and_b32 v185, 0xffff0000, v63
    v_add_f32 v184, v184, v167
    v_add_f32 v185, v185, v183
    v_cvt_pk_bf16_f32 v63, v184, v185
    buffer_store_dword v63, v79, s[28:31], 0 offen
    s_nop 0
MAIN_END:
    s_endpgm
.section .rodata,"a"
.p2align 6
.amdhsa_kernel prep_kernel
  .amdhsa_next_free_vgpr 64
  .amdhsa_next_free_sgpr 64
  .amdhsa_accum_offset 64
  .amdhsa_group_segment_fixed_size 0
  .amdhsa_kernarg_size 96
  .amdhsa_user_sgpr_count 2
  .amdhsa_user_sgpr_kernarg_segment_ptr 1
  .amdhsa_system_sgpr_workgroup_id_x 1
.end_amdhsa_kernel
.p2align 6
.amdhsa_kernel main_kernel
  .amdhsa_next_free_vgpr 256
  .amdhsa_next_free_sgpr 96
  .amdhsa_accum_offset 256
  .amdhsa_group_segment_fixed_size 0
  .amdhsa_kernarg_size 96
  .amdhsa_user_sgpr_count 2
  .amdhsa_user_sgpr_kernarg_segment_ptr 1
  .amdhsa_system_sgpr_workgroup_id_x 1
.end_amdhsa_kernel
```
